```python
import torch

def _softmax(x, axis=-1):
    return torch.softmax(x, dim=axis)
def _gelu(x):
    return torch.nn.functional.gelu(x, approximate="tanh")
def _silu(x):
    return torch.nn.functional.silu(x)
def _sigmoid(x):
    return torch.sigmoid(x)
def _layernorm(x, axis=-1, eps=1e-5):
    m = x.mean(dim=axis, keepdim=True)
    v = x.var(dim=axis, keepdim=True, unbiased=False)
    return (x - m) / torch.sqrt(v + eps)
def _scatter_add(tgt, idx, src, axis=0):
    return tgt.clone().index_add_(axis, idx, src)
def _segment_sum(src, seg, n):
    out = torch.zeros((n,) + src.shape[1:], dtype=src.dtype)
    return out.index_add_(0, seg, src)
def _pad(x, pw):
    flat = tuple(v for pair in reversed(pw) for v in pair)
    return torch.nn.functional.pad(x, flat)

kernel_name = 'concat_heads__ssm_conv_h3__softmax_full_mha__prompt'

def setup_inputs():

    _w = (lambda a: (lambda t: t.to(torch.bfloat16) if t.is_floating_point() else t)(torch.as_tensor(a)))
    def _A_setup():
        B, S, D = 1, 2048, 512
        ks = 4
        return {
            "q": _w((lambda *s: torch.randn(*s, dtype=torch.bfloat16) * 0.05)(B, S, D)),
            "k": _w((lambda *s: torch.randn(*s, dtype=torch.bfloat16) * 0.4)(B, S, D)),
            "v": _w((lambda *s: torch.randn(*s, dtype=torch.bfloat16) * 0.4)(B, S, D)),
            "shift_k": _w((lambda *s: torch.randn(*s, dtype=torch.bfloat16) * 0.4)(D, ks) * 0.5),
            "ssm_k": _w((lambda *s: torch.randn(*s, dtype=torch.bfloat16) * 1.6)(D, S) * (1.0 / S ** 0.5)),
            "ssm_D": _w((lambda *s: torch.randn(*s, dtype=torch.bfloat16) * 0.4)(D)),
        }
    _A_in = _A_setup()

    def _B_setup():
        B, S, D = 1, 2048, 512
        return {
            "x": _w((lambda *s: torch.randn(*s, dtype=torch.bfloat16) * 0.2)(B, S, D)),
            "wqkv": _w((lambda *s: torch.randn(*s, dtype=torch.bfloat16) * 0.2)(D, 3 * D)),
            "wo": _w((lambda *s: torch.randn(*s, dtype=torch.bfloat16) * 0.05)(D, D)),
        }
    _B_in = _B_setup()

    return {
        "A_q": _A_in["q"],
        "A_k": _A_in["k"],
        "A_v": _A_in["v"],
        "A_shift_k": _A_in["shift_k"],
        "A_ssm_k": _A_in["ssm_k"],
        "A_ssm_D": _A_in["ssm_D"],
        "B_x": _B_in["x"],
        "B_wqkv": _B_in["wqkv"],
        "B_wo": _B_in["wo"],
    }

def reference(A_q, A_k, A_v, A_shift_k, A_ssm_k, A_ssm_D, B_x, B_wqkv, B_wo):
    def _A_ref(q, k, v, shift_k, ssm_k, ssm_D):
        B, S, D = q.shape
        ks = shift_k.shape[-1]
        k_pad = _pad(k, ((0, 0), (ks - 1, 0), (0, 0)))
        k_shift = torch.zeros_like(k)
        for t in range(ks):
            k_shift = k_shift + k_pad[:, t:t + S, :] * shift_k[:, ks - 1 - t][None, None, :]
        kv = k_shift * v
        L = 2 * S
        kv_pad = _pad(kv, ((0, 0), (0, S), (0, 0)))
        kf_pad = _pad(ssm_k, ((0, 0), (0, S)))
        kv_f = (lambda x, axes=(-2,-1): torch.fft.rfft2(x.float(), dim=axes))(kv_pad[:, None, :, :], axes=(1, 2))
        kf_f = (lambda x, axes=(-2,-1): torch.fft.rfft2(x.float(), dim=axes))(kf_pad[:, None, :], axes=(1, 2))
        kf_f = (lambda x, *d: x.permute(*d))(kf_f, 1, 2, 0)
        y_f = kv_f * kf_f[None, :, :, :]
        y = (lambda x, s, axes=(-2,-1): torch.fft.irfft2(x, s=s, dim=axes).to(torch.bfloat16))(y_f, (1, L), axes=(1, 2))[:, 0, :S, :]
        y = y + kv * ssm_D[None, None, :]
        return q * y

    def _B_ref(x, wqkv, wo):
        B, S, D = x.shape
        H = 32; Dh = D // H
        qkv = (lambda x, *d: x.permute(*d))((x @ wqkv).reshape(B, S, 3, H, Dh), 2, 0, 3, 1, 4)
        q, k, v = qkv[0], qkv[1], qkv[2]
        scale = Dh ** -0.5
        scores = torch.einsum("bhqd,bhkd->bhqk", q, k) * scale
        p = _softmax(scores, axis=-1)
        o = torch.einsum("bhqk,bhkd->bhqd", p, v)
        return (lambda x, *d: x.permute(*d))(o, 0, 2, 1, 3).reshape(B, S, D) @ wo

    a = _A_ref(A_q, A_k, A_v, A_shift_k, A_ssm_k, A_ssm_D)
    b = _B_ref(B_x, B_wqkv, B_wo)
    return torch.concatenate([a, b], axis=-1)
```

```asm
; @launch grid=(256,1,1) block=(768,1,1) lds=163840
.amdgcn_target "amdgcn-amd-amdhsa--gfx950"
.text
.globl concat_heads__ssm_conv_h3__softmax_full_mha__prompt_kernel
.p2align 10
.p2align 8
.type concat_heads__ssm_conv_h3__softmax_full_mha__prompt_kernel,@function
concat_heads__ssm_conv_h3__softmax_full_mha__prompt_kernel:
    s_cmp_ge_u32 s2, 256
    s_cbranch_scc1 END
    s_load_dwordx16 s[4:19], s[0:1], 0
    s_load_dwordx8 s[20:27], s[0:1], 64
    v_lshrrev_b32 v1, 6, v0
    v_and_b32 v2, 63, v0
    v_readfirstlane_b32 s3, v1
    v_lshlrev_b32 v3, 4, v2
    s_and_b32 s48, s2, 7
    s_lshr_b32 s49, s2, 3
    s_and_b32 s50, s49, 3
    s_lshr_b32 s51, s49, 2
    s_and_b32 s52, s48, 4
    s_add_u32 s52, s52, s50
    s_and_b32 s53, s48, 3
    s_lshl_b32 s53, s53, 3
    s_add_u32 s53, s53, s51
    s_lshl_b32 s54, s48, 2
    s_add_u32 s54, s54, s50
    s_lshl_b32 s55, s50, 1
    s_add_u32 s55, s55, s51
    s_and_b32 s55, s55, 7
    s_lshl_b32 s66, s48, 5
    s_add_u32 s66, s66, s49
    v_mov_b32 v1, 163080
    v_mov_b32 v54, 1
    v_mov_b32 v13, 0
    s_cmp_lt_u32 s3, 8
    s_cbranch_scc1 CPATH
    s_setprio 3
    v_lshrrev_b32 v4, 3, v2
    v_lshrrev_b32 v5, 4, v2
    v_and_b32 v6, 7, v2
    v_lshlrev_b32 v12, 6, v2
    s_cmp_eq_u32 s3, 8
    s_cbranch_scc1 XL0
    s_cmp_lg_u32 s3, 9
    s_cbranch_scc1 HPATH
    s_getpc_b64 s[56:57]
    s_lshl_b32 s58, s50, 13
    v_lshlrev_b32 v7, 7, v2
    v_add_u32 v7, s58, v7
    v_min_u32 v7, END - concat_heads__ssm_conv_h3__softmax_full_mha__prompt_kernel - 256, v7
    global_load_dword v31, v7, s[56:57]
    s_branch LQPAD
XL0:
    s_setprio 2
    v_lshlrev_b32 v10, 4, v6
    v_lshl_add_u32 v10, v4, 10, v10
    s_lshl_b32 s63, s49, 16
    s_lshl_b32 s64, s48, 7
    s_add_u32 s63, s63, s64
    v_add_u32 v28, s63, v10
    v_subrev_u32 v10, 8192, v28
    v_add_u32 v29, 7168, v28
    v_add_u32 v30, 7168, v29
    v_add_u32 v31, 7168, v30
    v_xor_b32 v7, v6, v5
    v_lshlrev_b32 v7, 4, v7
    v_lshl_add_u32 v16, v4, 10, v7
    v_xor_b32 v17, 64, v16
    v_add_u32 v17, 7168, v17
    v_add_u32 v18, 14336, v16
    v_add_u32 v19, 14336, v17
    v_bfe_u32 v7, v2, 2, 2
    v_xor_b32 v7, v7, v5
    v_mul_u32_u24 v8, 3072, v5
    v_lshrrev_b32 v9, 1, v7
    v_lshl_add_u32 v8, v9, 10, v8
    v_and_b32 v9, 1, v7
    v_lshl_add_u32 v8, v9, 6, v8
    v_and_b32 v9, 3, v2
    v_lshl_add_u32 v20, v9, 4, v8
    v_add_u32 v21, 11264, v20
    v_add_u32 v22, 11264, v21
    v_add_u32 v23, 11264, v22
    s_lshl_b32 s62, s48, 9
    s_lshl_b32 s57, s53, 16
    s_lshl_b32 s58, s52, 7
    s_mov_b32 s59, s55
    s_mov_b32 s56, 0
    s_mov_b32 s63, 32768
    s_mov_b32 m0, 131072
    s_waitcnt lgkmcnt(0)
    s_mov_b32 s40, s6
    s_and_b32 s41, s7, 0xffff
    s_mov_b32 s42, 2097152
    s_mov_b32 s43, 0x00020000
    buffer_load_dwordx4 v10, s[40:43], 0 offen lds
    s_mov_b32 m0, 132096
    s_nop 0
    buffer_load_dwordx4 v28, s[40:43], 0 offen offset:0 lds
    buffer_load_dwordx4 v29, s[40:43], 0 offen offset:1024 lds
    buffer_load_dwordx4 v30, s[40:43], 0 offen offset:2048 lds
    buffer_load_dwordx4 v31, s[40:43], 0 offen offset:3072 lds
    s_mov_b32 m0, 136192
    s_nop 0
    buffer_load_dwordx4 v28, s[40:43], s63 offen offset:0 lds
    buffer_load_dwordx4 v29, s[40:43], s63 offen offset:1024 lds
    buffer_load_dwordx4 v30, s[40:43], s63 offen offset:2048 lds
    buffer_load_dwordx4 v31, s[40:43], s63 offen offset:3072 lds
    s_mov_b32 s40, s8
    s_and_b32 s41, s9, 0xffff
    s_mov_b32 m0, 140288
    s_nop 0
    buffer_load_dwordx4 v28, s[40:43], 0 offen offset:0 lds
    buffer_load_dwordx4 v29, s[40:43], 0 offen offset:1024 lds
    buffer_load_dwordx4 v30, s[40:43], 0 offen offset:2048 lds
    buffer_load_dwordx4 v31, s[40:43], 0 offen offset:3072 lds
    s_mov_b32 m0, 144384
    s_nop 0
    buffer_load_dwordx4 v28, s[40:43], s63 offen offset:0 lds
    buffer_load_dwordx4 v29, s[40:43], s63 offen offset:1024 lds
    buffer_load_dwordx4 v30, s[40:43], s63 offen offset:2048 lds
    buffer_load_dwordx4 v31, s[40:43], s63 offen offset:3072 lds
    s_mov_b32 s40, s10
    s_and_b32 s41, s11, 0xffff
    s_movk_i32 s42, 4096
    s_mov_b32 m0, 148480
    s_mov_b32 exec_hi, 0
    buffer_load_dwordx4 v3, s[40:43], s62 offen lds
    s_mov_b64 exec, -1
    s_mov_b32 s32, s16
    s_and_b32 s33, s17, 0xffff
    s_mov_b32 s34, 2097152
    s_mov_b32 s35, 0x00020000
    s_mov_b32 s36, s18
    s_and_b32 s37, s19, 0xffff
    s_mov_b32 s38, 1572864
    s_mov_b32 s39, 0x00020000
    s_branch XLB
XL:
    s_cmp_eq_u32 s56, 2
    s_cbranch_scc1 XLB
    s_cmp_eq_u32 s56, 1
    s_cbranch_scc0 XLC
    s_waitcnt vmcnt(24)
XLC:
    s_waitcnt vmcnt(48)
    s_barrier
XLB:
    s_lshl_b32 s67, s56, 13
    s_mov_b32 m0, s67
    s_lshl_b32 s64, s59, 7
    s_add_u32 s64, s64, s57
    buffer_load_dwordx4 v16, s[32:35], s64 offen offset:0 lds
    buffer_load_dwordx4 v17, s[32:35], s64 offen offset:1024 lds
    buffer_load_dwordx4 v18, s[32:35], s64 offen offset:2048 lds
    buffer_load_dwordx4 v19, s[32:35], s64 offen offset:3072 lds
    s_add_u32 m0, s67, 4096
    s_add_u32 s64, s64, 32768
    buffer_load_dwordx4 v16, s[32:35], s64 offen offset:0 lds
    buffer_load_dwordx4 v17, s[32:35], s64 offen offset:1024 lds
    buffer_load_dwordx4 v18, s[32:35], s64 offen offset:2048 lds
    buffer_load_dwordx4 v19, s[32:35], s64 offen offset:3072 lds
    s_and_b32 s67, s56, 3
    s_lshl_b32 s67, s67, 14
    s_add_u32 m0, s67, 65536
    s_mul_i32 s65, s59, 196608
    s_add_u32 s65, s65, s58
    s_add_u32 s65, s65, 1024
    buffer_load_dwordx4 v20, s[36:39], s65 offen offset:0 lds
    buffer_load_dwordx4 v21, s[36:39], s65 offen offset:1024 lds
    buffer_load_dwordx4 v22, s[36:39], s65 offen offset:2048 lds
    buffer_load_dwordx4 v23, s[36:39], s65 offen offset:3072 lds
    s_add_u32 m0, m0, 4096
    s_add_u32 s65, s65, 49152
    buffer_load_dwordx4 v20, s[36:39], s65 offen offset:0 lds
    buffer_load_dwordx4 v21, s[36:39], s65 offen offset:1024 lds
    buffer_load_dwordx4 v22, s[36:39], s65 offen offset:2048 lds
    buffer_load_dwordx4 v23, s[36:39], s65 offen offset:3072 lds
    s_add_u32 m0, m0, 4096
    s_add_u32 s65, s65, 49152
    buffer_load_dwordx4 v20, s[36:39], s65 offen offset:0 lds
    buffer_load_dwordx4 v21, s[36:39], s65 offen offset:1024 lds
    buffer_load_dwordx4 v22, s[36:39], s65 offen offset:2048 lds
    buffer_load_dwordx4 v23, s[36:39], s65 offen offset:3072 lds
    s_add_u32 m0, m0, 4096
    s_add_u32 s65, s65, 49152
    buffer_load_dwordx4 v20, s[36:39], s65 offen offset:0 lds
    buffer_load_dwordx4 v21, s[36:39], s65 offen offset:1024 lds
    buffer_load_dwordx4 v22, s[36:39], s65 offen offset:2048 lds
    buffer_load_dwordx4 v23, s[36:39], s65 offen offset:3072 lds
    s_cmp_eq_u32 s56, 3
    s_addc_u32 s59, s59, 2
    s_and_b32 s59, s59, 7
    s_add_u32 s56, s56, 1
    s_cmp_lt_u32 s56, 8
    s_cbranch_scc1 XL
    s_branch LQ2
CPATH:
C_NN:
    v_and_b32 v4, 31, v2
    v_lshrrev_b32 v5, 5, v2
    v_bfe_u32 v63, v2, 1, 3
    v_xor_b32 v63, v63, v5
    s_and_b32 s56, s3, 1
    s_lshl_b32 s56, s56, 12
    v_lshlrev_b32 v61, 7, v4
    v_add_u32 v61, s56, v61
    v_xor_b32 v60, 0, v63
    v_lshl_add_u32 v56, v60, 4, v61
    v_xor_b32 v60, 2, v63
    v_lshl_add_u32 v57, v60, 4, v61
    v_xor_b32 v60, 4, v63
    v_lshl_add_u32 v58, v60, 4, v61
    v_xor_b32 v60, 6, v63
    v_lshl_add_u32 v59, v60, 4, v61
    v_bfe_u32 v61, v2, 2, 2
    v_lshl_add_u32 v62, v5, 3, v61
    v_lshlrev_b32 v60, 8, v62
    v_bfe_u32 v63, v2, 4, 1
    v_lshl_add_u32 v60, v63, 5, v60
    v_and_b32 v63, 3, v2
    v_lshl_add_u32 v60, v63, 3, v60
    s_lshr_b32 s56, s3, 1
    v_xor_b32 v63, s56, v61
    v_lshl_add_u32 v60, v63, 6, v60
    v_add_u32 v60, 65536, v60
    v_mov_b32 v64, 0
    v_mov_b32 v65, 0
    v_mov_b32 v66, 0
    v_mov_b32 v67, 0
    v_mov_b32 v68, 0
    v_mov_b32 v69, 0
    v_mov_b32 v70, 0
    v_mov_b32 v71, 0
    v_mov_b32 v72, 0
    v_mov_b32 v73, 0
    v_mov_b32 v74, 0
    v_mov_b32 v75, 0
    v_mov_b32 v76, 0
    v_mov_b32 v77, 0
    v_mov_b32 v78, 0
    v_mov_b32 v79, 0
    v_mov_b32 v80, 0
    v_mov_b32 v81, 0
    v_mov_b32 v82, 0
    v_mov_b32 v83, 0
    v_mov_b32 v84, 0
    v_mov_b32 v85, 0
    v_mov_b32 v86, 0
    v_mov_b32 v87, 0
    v_mov_b32 v88, 0
    v_mov_b32 v89, 0
    v_mov_b32 v90, 0
    v_mov_b32 v91, 0
    v_mov_b32 v92, 0
    v_mov_b32 v93, 0
    v_mov_b32 v94, 0
    v_mov_b32 v95, 0
    s_lshl_b32 s56, s52, 2
    s_and_b32 s57, s3, 2
    s_add_u32 s56, s56, s57
    s_lshl_b32 s56, s56, 6
    s_lshl_b32 s57, s53, 1
    s_add_u32 s56, s56, s57
    s_and_b32 s57, s3, 1
    s_add_u32 s64, s56, s57
    s_lshl_b32 s56, s64, 11
    s_mov_b32 s59, 0xffff0000
    s_waitcnt lgkmcnt(0)
    v_lshlrev_b32 v11, 4, v4
    v_add_u32 v11, 148480, v11
    s_mov_b32 s28, s26
    s_and_b32 s29, s27, 0xffff
    s_mov_b32 s30, 18874368
    s_mov_b32 s31, 0x00020000
    s_mov_b32 s32, s4
    s_and_b32 s33, s5, 0xffff
    s_mov_b32 s34, 2097152
    s_mov_b32 s35, 0x00020000
    s_mov_b32 s36, s22
    s_and_b32 s37, s23, 0xffff
    s_mov_b32 s38, 4194304
    s_mov_b32 s39, 0x00020000
    s_lshl_b32 s67, s66, 2
    s_load_dword s68, s[14:15], s67
    s_lshl_b32 s57, s3, 10
    v_lshlrev_b32 v10, 9, v5
    v_lshl_add_u32 v10, v4, 2, v10
    v_add_u32 v10, s57, v10
    v_add_u32 v0, s57, v3
    s_sub_u32 s57, 7, s3
    v_and_b32 v12, 7, v4
    v_xor_b32 v12, s57, v12
    v_lshlrev_b32 v12, 4, v12
    v_lshl_add_u32 v12, v4, 8, v12
    v_lshlrev_b32 v9, 3, v5
    v_sub_u32 v12, v12, v9
    s_lshl_b32 s57, s3, 2
    v_lshrrev_b32 v8, 4, v2
    v_add_u32 v8, s57, v8
    v_xor_b32 v8, v8, v2
    v_and_b32 v8, 7, v8
    v_lshlrev_b32 v8, 4, v8
    v_lshrrev_b32 v9, 3, v2
    v_lshl_add_u32 v8, v9, 12, v8
    s_lshl_b32 s65, s48, 18
    s_lshl_b32 s57, s3, 15
    s_add_u32 s65, s65, s57
    s_sub_u32 s57, 31, s49
    s_lshl_b32 s57, s57, 7
    s_add_u32 s65, s65, s57
    v_mov_b32 v54, 1
    v_add_u32 v10, 131072, v10
    v_add_u32 v12, 149512, v12
    v_add_u32 v0, 149504, v0
    s_add_u32 s65, s65, 8388608
    v_and_b32 v7, 0x33, v2
    v_bfe_u32 v6, v2, 2, 1
    v_lshl_or_b32 v7, v6, 3, v7
    v_bfe_u32 v6, v2, 3, 1
    v_lshl_or_b32 v7, v6, 2, v7
    v_lshlrev_b32 v7, 4, v7
    v_lshlrev_b32 v61, 7, v62
    v_bfe_u32 v63, v2, 4, 1
    v_lshl_add_u32 v61, v63, 5, v61
    v_lshlrev_b32 v9, 17, v63
    v_and_b32 v63, 3, v2
    v_lshl_add_u32 v61, v63, 3, v61
    v_bfe_u32 v63, v2, 3, 1
    s_lshr_b32 s58, s3, 1
    v_xor_b32 v63, s58, v63
    v_lshl_add_u32 v61, v63, 6, v61
    v_lshl_add_u32 v9, v5, 8, v9
    v_and_b32 v6, 15, v2
    v_lshl_add_u32 v9, v6, 4, v9
    v_add_u32 v61, 65536, v61
    s_add_u32 s56, s56, 2097152
    s_add_u32 s57, s56, 131072
    s_barrier
    ds_read_b128 v[140:143], v11
    ds_read_b32 v128, v10 offset:640
    ds_read_b32 v129, v10 offset:768
    ds_read_b32 v130, v10 offset:896
    ds_read_b32 v131, v10 offset:1024
    ds_read_b32 v132, v10 offset:1152
    ds_read_b32 v133, v10 offset:1280
    ds_read_b32 v134, v10 offset:1408
    ds_read_b32 v135, v10 offset:9216
    ds_read_b32 v136, v10 offset:9344
    ds_read_b32 v137, v10 offset:9472
    ds_read_b32 v138, v10 offset:9600
    s_waitcnt lgkmcnt(0)
    v_lshlrev_b32 v144, 16, v128
    v_lshlrev_b32 v145, 16, v129
    v_lshlrev_b32 v146, 16, v130
    v_lshlrev_b32 v147, 16, v131
    v_lshlrev_b32 v148, 16, v132
    v_lshlrev_b32 v149, 16, v133
    v_lshlrev_b32 v150, 16, v134
    v_lshlrev_b32 v152, 16, v140
    v_and_b32 v153, s59, v140
    v_lshlrev_b32 v154, 16, v141
    v_and_b32 v155, s59, v141
    v_lshlrev_b32 v156, 16, v135
    v_lshlrev_b32 v157, 16, v136
    v_lshlrev_b32 v158, 16, v137
    v_lshlrev_b32 v159, 16, v138
    v_mul_f32 v160, v144, v155
    v_mul_f32 v161, v145, v155
    v_mul_f32 v162, v146, v155
    v_mul_f32 v163, v147, v155
    v_fmac_f32 v160, v145, v154
    v_fmac_f32 v161, v146, v154
    v_fmac_f32 v162, v147, v154
    v_fmac_f32 v163, v148, v154
    v_fmac_f32 v160, v146, v153
    v_fmac_f32 v161, v147, v153
    v_fmac_f32 v162, v148, v153
    v_fmac_f32 v163, v149, v153
    v_fmac_f32 v160, v147, v152
    v_fmac_f32 v161, v148, v152
    v_fmac_f32 v162, v149, v152
    v_fmac_f32 v163, v150, v152
    v_mul_f32 v156, v156, v160
    v_mul_f32 v157, v157, v161
    v_mul_f32 v158, v158, v162
    v_mul_f32 v159, v159, v163
    v_cvt_pk_bf16_f32 v164, v159, v158
    v_cvt_pk_bf16_f32 v165, v157, v156
    ds_write_b64 v12, v[164:165] offset:0
    v_and_b32 v144, s59, v128
    v_and_b32 v145, s59, v129
    v_and_b32 v146, s59, v130
    v_and_b32 v147, s59, v131
    v_and_b32 v148, s59, v132
    v_and_b32 v149, s59, v133
    v_and_b32 v150, s59, v134
    v_lshlrev_b32 v152, 16, v142
    v_and_b32 v153, s59, v142
    v_lshlrev_b32 v154, 16, v143
    v_and_b32 v155, s59, v143
    v_and_b32 v156, s59, v135
    v_and_b32 v157, s59, v136
    v_and_b32 v158, s59, v137
    v_and_b32 v159, s59, v138
    v_mul_f32 v160, v144, v155
    v_mul_f32 v161, v145, v155
    v_mul_f32 v162, v146, v155
    v_mul_f32 v163, v147, v155
    v_fmac_f32 v160, v145, v154
    v_fmac_f32 v161, v146, v154
    v_fmac_f32 v162, v147, v154
    v_fmac_f32 v163, v148, v154
    v_fmac_f32 v160, v146, v153
    v_fmac_f32 v161, v147, v153
    v_fmac_f32 v162, v148, v153
    v_fmac_f32 v163, v149, v153
    v_fmac_f32 v160, v147, v152
    v_fmac_f32 v161, v148, v152
    v_fmac_f32 v162, v149, v152
    v_fmac_f32 v163, v150, v152
    v_mul_f32 v156, v156, v160
    v_mul_f32 v157, v157, v161
    v_mul_f32 v158, v158, v162
    v_mul_f32 v159, v159, v163
    v_cvt_pk_bf16_f32 v166, v159, v158
    v_cvt_pk_bf16_f32 v167, v157, v156
    ds_write_b64 v12, v[166:167] offset:128
    s_waitcnt lgkmcnt(0)
    s_cmp_ge_u32 s3, 4
    s_cbranch_scc1 VPATH
    s_barrier
    ds_read_b128 v[48:51], v0
    ds_read_b128 v[16:19], v56 offset:0
    ds_read_b64_tr_b16 v[20:21], v60 offset:0
    ds_read_b64_tr_b16 v[22:23], v60 offset:1024
    ds_read_b128 v[24:27], v57 offset:0
    ds_read_b64_tr_b16 v[28:29], v60 offset:4096
    ds_read_b64_tr_b16 v[30:31], v60 offset:5120
    ds_read_b128 v[32:35], v58 offset:0
    ds_read_b64_tr_b16 v[36:37], v60 offset:8192
    ds_read_b64_tr_b16 v[38:39], v60 offset:9216
    ds_read_b128 v[40:43], v59 offset:0
    ds_read_b64_tr_b16 v[44:45], v60 offset:12288
    ds_read_b64_tr_b16 v[46:47], v60 offset:13312
    s_waitcnt lgkmcnt(12)
    buffer_store_dwordx4 v[48:51], v8, s[28:31], s65 offen sc1
    s_waitcnt lgkmcnt(0)
    s_barrier
    ds_read_b128 v[96:99], v56 offset:8192
    ds_read_b64_tr_b16 v[100:101], v60 offset:16384
    ds_read_b64_tr_b16 v[102:103], v60 offset:17408
    ds_read_b128 v[104:107], v57 offset:8192
    ds_read_b64_tr_b16 v[108:109], v60 offset:20480
    ds_read_b64_tr_b16 v[110:111], v60 offset:21504
    ds_read_b128 v[112:115], v58 offset:8192
    ds_read_b64_tr_b16 v[116:117], v60 offset:24576
    ds_read_b64_tr_b16 v[118:119], v60 offset:25600
    ds_read_b128 v[120:123], v59 offset:8192
    ds_read_b64_tr_b16 v[124:125], v60 offset:28672
    ds_read_b64_tr_b16 v[126:127], v60 offset:29696
    v_mfma_f32_32x32x16_bf16 v[64:79], v[20:23], v[16:19], v[64:79]
    v_mfma_f32_32x32x16_bf16 v[64:79], v[28:31], v[24:27], v[64:79]
    v_mfma_f32_32x32x16_bf16 v[64:79], v[36:39], v[32:35], v[64:79]
    v_mfma_f32_32x32x16_bf16 v[64:79], v[44:47], v[40:43], v[64:79]
    s_waitcnt lgkmcnt(0)
    s_barrier
    ds_read_b128 v[16:19], v56 offset:16384
    ds_read_b64_tr_b16 v[20:21], v60 offset:32768
    ds_read_b64_tr_b16 v[22:23], v60 offset:33792
    ds_read_b128 v[24:27], v57 offset:16384
    ds_read_b64_tr_b16 v[28:29], v60 offset:36864
    ds_read_b64_tr_b16 v[30:31], v60 offset:37888
    ds_read_b128 v[32:35], v58 offset:16384
    ds_read_b64_tr_b16 v[36:37], v60 offset:40960
    ds_read_b64_tr_b16 v[38:39], v60 offset:41984
    ds_read_b128 v[40:43], v59 offset:16384
    ds_read_b64_tr_b16 v[44:45], v60 offset:45056
    ds_read_b64_tr_b16 v[46:47], v60 offset:46080
    v_mfma_f32_32x32x16_bf16 v[64:79], v[100:103], v[96:99], v[64:79]
    v_mfma_f32_32x32x16_bf16 v[64:79], v[108:111], v[104:107], v[64:79]
    v_mfma_f32_32x32x16_bf16 v[64:79], v[116:119], v[112:115], v[64:79]
    v_mfma_f32_32x32x16_bf16 v[64:79], v[124:127], v[120:123], v[64:79]
    s_waitcnt lgkmcnt(0)
    s_barrier
    ds_read_b128 v[96:99], v56 offset:24576
    ds_read_b64_tr_b16 v[100:101], v60 offset:49152
    ds_read_b64_tr_b16 v[102:103], v60 offset:50176
    ds_read_b128 v[104:107], v57 offset:24576
    ds_read_b64_tr_b16 v[108:109], v60 offset:53248
    ds_read_b64_tr_b16 v[110:111], v60 offset:54272
    ds_read_b128 v[112:115], v58 offset:24576
    ds_read_b64_tr_b16 v[116:117], v60 offset:57344
    ds_read_b64_tr_b16 v[118:119], v60 offset:58368
    ds_read_b128 v[120:123], v59 offset:24576
    ds_read_b64_tr_b16 v[124:125], v60 offset:61440
    ds_read_b64_tr_b16 v[126:127], v60 offset:62464
    v_mfma_f32_32x32x16_bf16 v[64:79], v[20:23], v[16:19], v[64:79]
    v_mfma_f32_32x32x16_bf16 v[64:79], v[28:31], v[24:27], v[64:79]
    v_mfma_f32_32x32x16_bf16 v[64:79], v[36:39], v[32:35], v[64:79]
    v_mfma_f32_32x32x16_bf16 v[64:79], v[44:47], v[40:43], v[64:79]
    s_waitcnt lgkmcnt(0)
    s_waitcnt vmcnt(0)
    s_barrier
    ds_read_b128 v[16:19], v56 offset:32768
    ds_read_b64_tr_b16 v[20:21], v60 offset:0
    ds_read_b64_tr_b16 v[22:23], v60 offset:1024
    ds_read_b128 v[24:27], v57 offset:32768
    ds_read_b64_tr_b16 v[28:29], v60 offset:4096
    ds_read_b64_tr_b16 v[30:31], v60 offset:5120
    ds_read_b128 v[32:35], v58 offset:32768
    ds_read_b64_tr_b16 v[36:37], v60 offset:8192
    ds_read_b64_tr_b16 v[38:39], v60 offset:9216
    ds_read_b128 v[40:43], v59 offset:32768
    ds_read_b64_tr_b16 v[44:45], v60 offset:12288
    ds_read_b64_tr_b16 v[46:47], v60 offset:13312
    v_mfma_f32_32x32x16_bf16 v[64:79], v[100:103], v[96:99], v[64:79]
    v_mfma_f32_32x32x16_bf16 v[64:79], v[108:111], v[104:107], v[64:79]
    v_mfma_f32_32x32x16_bf16 v[64:79], v[116:119], v[112:115], v[64:79]
    v_mfma_f32_32x32x16_bf16 v[64:79], v[124:127], v[120:123], v[64:79]
    s_waitcnt lgkmcnt(0)
    s_barrier
    ds_read_b128 v[96:99], v56 offset:40960
    ds_read_b64_tr_b16 v[100:101], v60 offset:16384
    ds_read_b64_tr_b16 v[102:103], v60 offset:17408
    ds_read_b128 v[104:107], v57 offset:40960
    ds_read_b64_tr_b16 v[108:109], v60 offset:20480
    ds_read_b64_tr_b16 v[110:111], v60 offset:21504
    ds_read_b128 v[112:115], v58 offset:40960
    ds_read_b64_tr_b16 v[116:117], v60 offset:24576
    ds_read_b64_tr_b16 v[118:119], v60 offset:25600
    ds_read_b128 v[120:123], v59 offset:40960
    ds_read_b64_tr_b16 v[124:125], v60 offset:28672
    ds_read_b64_tr_b16 v[126:127], v60 offset:29696
    v_mfma_f32_32x32x16_bf16 v[64:79], v[20:23], v[16:19], v[64:79]
    v_mfma_f32_32x32x16_bf16 v[64:79], v[28:31], v[24:27], v[64:79]
    v_mfma_f32_32x32x16_bf16 v[64:79], v[36:39], v[32:35], v[64:79]
    v_mfma_f32_32x32x16_bf16 v[64:79], v[44:47], v[40:43], v[64:79]
    s_waitcnt lgkmcnt(0)
    s_barrier
    ds_read_b128 v[16:19], v56 offset:49152
    ds_read_b64_tr_b16 v[20:21], v60 offset:32768
    ds_read_b64_tr_b16 v[22:23], v60 offset:33792
    ds_read_b128 v[24:27], v57 offset:49152
    ds_read_b64_tr_b16 v[28:29], v60 offset:36864
    ds_read_b64_tr_b16 v[30:31], v60 offset:37888
    ds_read_b128 v[32:35], v58 offset:49152
    ds_read_b64_tr_b16 v[36:37], v60 offset:40960
    ds_read_b64_tr_b16 v[38:39], v60 offset:41984
    ds_read_b128 v[40:43], v59 offset:49152
    ds_read_b64_tr_b16 v[44:45], v60 offset:45056
    ds_read_b64_tr_b16 v[46:47], v60 offset:46080
    v_mfma_f32_32x32x16_bf16 v[64:79], v[100:103], v[96:99], v[64:79]
    v_mfma_f32_32x32x16_bf16 v[64:79], v[108:111], v[104:107], v[64:79]
    v_mfma_f32_32x32x16_bf16 v[64:79], v[116:119], v[112:115], v[64:79]
    v_mfma_f32_32x32x16_bf16 v[64:79], v[124:127], v[120:123], v[64:79]
    s_waitcnt lgkmcnt(0)
    s_barrier
    ds_read_b128 v[96:99], v56 offset:57344
    ds_read_b64_tr_b16 v[100:101], v60 offset:49152
    ds_read_b64_tr_b16 v[102:103], v60 offset:50176
    ds_read_b128 v[104:107], v57 offset:57344
    ds_read_b64_tr_b16 v[108:109], v60 offset:53248
    ds_read_b64_tr_b16 v[110:111], v60 offset:54272
    ds_read_b128 v[112:115], v58 offset:57344
    ds_read_b64_tr_b16 v[116:117], v60 offset:57344
    ds_read_b64_tr_b16 v[118:119], v60 offset:58368
    ds_read_b128 v[120:123], v59 offset:57344
    ds_read_b64_tr_b16 v[124:125], v60 offset:61440
    ds_read_b64_tr_b16 v[126:127], v60 offset:62464
    v_mfma_f32_32x32x16_bf16 v[64:79], v[20:23], v[16:19], v[64:79]
    v_mfma_f32_32x32x16_bf16 v[64:79], v[28:31], v[24:27], v[64:79]
    v_mfma_f32_32x32x16_bf16 v[64:79], v[36:39], v[32:35], v[64:79]
    v_mfma_f32_32x32x16_bf16 v[64:79], v[44:47], v[40:43], v[64:79]
    s_waitcnt lgkmcnt(0)
    s_barrier
    s_setprio 2
    ds_read_b128 v[16:19], v56 offset:0
    ds_read_b64_tr_b16 v[20:21], v61 offset:0
    ds_read_b64_tr_b16 v[22:23], v61 offset:512
    ds_read_b128 v[24:27], v57 offset:0
    ds_read_b64_tr_b16 v[28:29], v61 offset:2048
    ds_read_b64_tr_b16 v[30:31], v61 offset:2560
    ds_read_b128 v[32:35], v58 offset:0
    ds_read_b64_tr_b16 v[36:37], v61 offset:4096
    ds_read_b64_tr_b16 v[38:39], v61 offset:4608
    ds_read_b128 v[40:43], v59 offset:0
    ds_read_b64_tr_b16 v[44:45], v61 offset:6144
    ds_read_b64_tr_b16 v[46:47], v61 offset:6656
    v_mfma_f32_32x32x16_bf16 v[64:79], v[100:103], v[96:99], v[64:79]
    v_mfma_f32_32x32x16_bf16 v[64:79], v[108:111], v[104:107], v[64:79]
    v_mfma_f32_32x32x16_bf16 v[64:79], v[116:119], v[112:115], v[64:79]
    v_mfma_f32_32x32x16_bf16 v[64:79], v[124:127], v[120:123], v[64:79]
    s_waitcnt lgkmcnt(9)
    v_mfma_f32_32x32x16_bf16 v[80:95], v[20:23], v[16:19], v[80:95]
    ds_read_b128 v[128:131], v56 offset:8192
    ds_read_b64_tr_b16 v[132:133], v61 offset:8192
    ds_read_b64_tr_b16 v[134:135], v61 offset:8704
    ds_read_b32 v55, v1 offset:4
    s_lshr_b32 s40, s3, 2
    s_and_b32 s41, s3, 3
    v_and_b32 v6, 1, v2
    v_and_b32 v4, 15, v2
    s_waitcnt lgkmcnt(10)
    v_mfma_f32_32x32x16_bf16 v[80:95], v[28:31], v[24:27], v[80:95]
    ds_read_b128 v[136:139], v57 offset:8192
    ds_read_b64_tr_b16 v[140:141], v61 offset:10240
    ds_read_b64_tr_b16 v[142:143], v61 offset:10752
    v_lshrrev_b32 v5, 4, v2
    v_mul_u32_u24 v6, 4162, v6
    v_sub_u32 v6, 150628, v6
    v_lshl_add_u32 v6, v4, 1, v6
    s_waitcnt lgkmcnt(10)
    v_mfma_f32_32x32x16_bf16 v[80:95], v[36:39], v[32:35], v[80:95]
    ds_read_b128 v[16:19], v58 offset:8192
    ds_read_b64_tr_b16 v[20:21], v61 offset:12288
    ds_read_b64_tr_b16 v[22:23], v61 offset:12800
    v_lshl_add_u32 v6, v5, 4, v6
    s_mul_i32 s45, s40, 8324
    s_lshl_b32 s46, s41, 7
    s_add_u32 s45, s45, s46
    s_waitcnt lgkmcnt(10)
    v_mfma_f32_32x32x16_bf16 v[80:95], v[44:47], v[40:43], v[80:95]
    ds_read_b128 v[24:27], v59 offset:8192
    ds_read_b64_tr_b16 v[28:29], v61 offset:14336
    ds_read_b64_tr_b16 v[30:31], v61 offset:14848
    v_add_u32 v144, s45, v6
    v_add_u32 v145, 1024, v144
    v_add_u32 v146, 2048, v144
    v_add_u32 v147, 3072, v144
    s_waitcnt lgkmcnt(10)
    v_mfma_f32_32x32x16_bf16 v[80:95], v[132:135], v[128:131], v[80:95]
    s_waitcnt lgkmcnt(9)
    v_cmp_gt_u32 vcc, 1, v55
    s_cbranch_vccz P2X15
P2W15:
    ds_read_b32 v55, v1 offset:4
    s_waitcnt lgkmcnt(0)
    v_cmp_gt_u32 vcc, 1, v55
    s_cbranch_vccnz P2W15
P2X15:
    ds_read_b128 v[32:35], v56 offset:16384
    ds_read_b64_tr_b16 v[36:37], v61 offset:16384
    ds_read_b64_tr_b16 v[38:39], v61 offset:16896
    v_lshlrev_b32 v6, 1, v4
    v_sub_u32 v6, v5, v6
    v_lshlrev_b32 v6, 4, v6
    s_mul_i32 s47, s40, 7680
    s_waitcnt lgkmcnt(9)
    v_mfma_f32_32x32x16_bf16 v[80:95], v[140:143], v[136:139], v[80:95]
    ds_read_b128 v[40:43], v57 offset:16384
    ds_read_b64_tr_b16 v[44:45], v61 offset:18432
    ds_read_b64_tr_b16 v[46:47], v61 offset:18944
    s_add_u32 s46, s47, s46
    s_add_u32 s46, s46, 131552
    v_add_u32 v148, s46, v6
    v_mov_b32 v0, 1
    s_waitcnt lgkmcnt(9)
    v_mfma_f32_32x32x16_bf16 v[80:95], v[20:23], v[16:19], v[80:95]
    ds_read_b128 v[128:131], v58 offset:16384
    ds_read_b64_tr_b16 v[132:133], v61 offset:20480
    ds_read_b64_tr_b16 v[134:135], v61 offset:20992
    s_lshl_b32 s46, s40, 2
    v_add_u32 v149, s46, v1
    s_lshl_b32 s46, s3, 13
    s_add_u32 s46, s46, 65536
    s_waitcnt lgkmcnt(9)
    v_mfma_f32_32x32x16_bf16 v[80:95], v[28:31], v[24:27], v[80:95]
    ds_read_b128 v[136:139], v59 offset:16384
    ds_read_b64_tr_b16 v[140:141], v61 offset:22528
    ds_read_b64_tr_b16 v[142:143], v61 offset:23040
    v_bfe_u32 v6, v2, 5, 1
    v_lshlrev_b32 v6, 7, v6
    v_xor_b32 v151, v3, v6
    v_add_u32 v151, s46, v151
    s_waitcnt lgkmcnt(9)
    v_mfma_f32_32x32x16_bf16 v[80:95], v[36:39], v[32:35], v[80:95]
    ds_read_b128 v[16:19], v56 offset:24576
    ds_read_b64_tr_b16 v[20:21], v61 offset:24576
    ds_read_b64_tr_b16 v[22:23], v61 offset:25088
    ds_read_b32 v55, v1 offset:4
    v_bfe_u32 v152, v2, 1, 4
    v_and_b32 v6, 1, v2
    v_lshlrev_b32 v4, 3, v6
    v_xor_b32 v152, v152, v4
    s_waitcnt lgkmcnt(10)
    v_mfma_f32_32x32x16_bf16 v[80:95], v[44:47], v[40:43], v[80:95]
    ds_read_b128 v[24:27], v57 offset:24576
    ds_read_b64_tr_b16 v[28:29], v61 offset:26624
    ds_read_b64_tr_b16 v[30:31], v61 offset:27136
    v_lshl_add_u32 v152, v6, 5, v152
    v_lshlrev_b32 v152, 4, v152
    v_lshrrev_b32 v6, 5, v2
    v_lshl_add_u32 v152, v6, 10, v152
    s_waitcnt lgkmcnt(10)
    v_mfma_f32_32x32x16_bf16 v[80:95], v[132:135], v[128:131], v[80:95]
    ds_read_b128 v[32:35], v58 offset:24576
    ds_read_b64_tr_b16 v[36:37], v61 offset:28672
    ds_read_b64_tr_b16 v[38:39], v61 offset:29184
    s_lshl_b32 s46, s41, 11
    s_lshl_b32 s45, s40, 15
    s_add_u32 s46, s46, s45
    s_add_u32 s46, s46, 65536
    s_waitcnt lgkmcnt(10)
    v_mfma_f32_32x32x16_bf16 v[80:95], v[140:143], v[136:139], v[80:95]
    ds_read_b128 v[40:43], v59 offset:24576
    ds_read_b64_tr_b16 v[44:45], v61 offset:30720
    ds_read_b64_tr_b16 v[46:47], v61 offset:31232
    v_add_u32 v152, s46, v152
    s_lshl_b32 s46, s41, 6
    s_sub_u32 s46, 255, s46
    v_sub_u32 v153, s46, v2
    s_waitcnt lgkmcnt(10)
    v_mfma_f32_32x32x16_bf16 v[80:95], v[20:23], v[16:19], v[80:95]
    s_waitcnt lgkmcnt(9)
    v_cmp_gt_u32 vcc, 2, v55
    s_cbranch_vccz P2X16
P2W16:
    ds_read_b32 v55, v1 offset:4
    s_waitcnt lgkmcnt(0)
    v_cmp_gt_u32 vcc, 2, v55
    s_cbranch_vccnz P2W16
P2X16:
    ds_read_b128 v[128:131], v56 offset:32768
    ds_read_b64_tr_b16 v[132:133], v61 offset:32768
    ds_read_b64_tr_b16 v[134:135], v61 offset:33280
    v_lshlrev_b32 v153, 4, v153
    s_add_u32 s47, s47, 131072
    v_add_u32 v153, s47, v153
    s_lshl_b32 s46, s40, 4
    s_waitcnt lgkmcnt(9)
    v_mfma_f32_32x32x16_bf16 v[80:95], v[28:31], v[24:27], v[80:95]
    ds_read_b128 v[136:139], v57 offset:32768
    ds_read_b64_tr_b16 v[140:141], v61 offset:34816
    ds_read_b64_tr_b16 v[142:143], v61 offset:35328
    s_lshr_b32 s43, s68, s46
    s_lshl_b32 s43, s43, 16
    s_lshl_b32 s42, s66, 1
    s_add_u32 s42, s42, s40
    s_waitcnt lgkmcnt(9)
    v_mfma_f32_32x32x16_bf16 v[80:95], v[36:39], v[32:35], v[80:95]
    ds_read_b128 v[16:19], v58 offset:32768
    ds_read_b64_tr_b16 v[20:21], v61 offset:36864
    ds_read_b64_tr_b16 v[22:23], v61 offset:37376
    s_lshl_b32 s42, s42, 12
    s_lshl_b32 s46, s41, 10
    s_add_u32 s42, s42, s46
    s_add_u32 s42, s42, 10485760
    s_waitcnt lgkmcnt(9)
    v_mfma_f32_32x32x16_bf16 v[80:95], v[44:47], v[40:43], v[80:95]
    ds_read_b128 v[24:27], v59 offset:32768
    ds_read_b64_tr_b16 v[28:29], v61 offset:38912
    ds_read_b64_tr_b16 v[30:31], v61 offset:39424
    s_lshl_b32 s55, s50, 3
    s_add_u32 s55, s55, s3
    s_lshl_b32 s55, s55, 14
    s_add_u32 s55, s55, 13631488
    s_waitcnt lgkmcnt(9)
    v_mfma_f32_32x32x16_bf16 v[80:95], v[132:135], v[128:131], v[80:95]
    ds_read_b128 v[32:35], v56 offset:40960
    ds_read_b64_tr_b16 v[36:37], v61 offset:40960
    ds_read_b64_tr_b16 v[38:39], v61 offset:41472
    ds_read_b32 v55, v1 offset:4
    v_lshrrev_b32 v154, 3, v2
    v_and_b32 v4, 7, v2
    v_lshlrev_b32 v154, 10, v154
    v_lshl_add_u32 v154, v4, 4, v154
    s_waitcnt lgkmcnt(10)
    v_mfma_f32_32x32x16_bf16 v[80:95], v[140:143], v[136:139], v[80:95]
    ds_read_b128 v[40:43], v57 offset:40960
    ds_read_b64_tr_b16 v[44:45], v61 offset:43008
    ds_read_b64_tr_b16 v[46:47], v61 offset:43520
    s_lshl_b32 s44, s49, 16
    s_lshl_b32 s46, s3, 13
    s_add_u32 s44, s44, s46
    s_lshl_b32 s46, s48, 7
    s_waitcnt lgkmcnt(10)
    v_mfma_f32_32x32x16_bf16 v[80:95], v[20:23], v[16:19], v[80:95]
    ds_read_b128 v[128:131], v58 offset:40960
    ds_read_b64_tr_b16 v[132:133], v61 offset:45056
    ds_read_b64_tr_b16 v[134:135], v61 offset:45568
    s_add_u32 s44, s44, s46
    s_mov_b32 s66, 0xffff
    s_mov_b32 s67, 0xffff
    s_mov_b32 s68, 0
    s_waitcnt lgkmcnt(10)
    v_mfma_f32_32x32x16_bf16 v[80:95], v[28:31], v[24:27], v[80:95]
    ds_read_b128 v[136:139], v59 offset:40960
    ds_read_b64_tr_b16 v[140:141], v61 offset:47104
    ds_read_b64_tr_b16 v[142:143], v61 offset:47616
    s_lshl_b32 s46, s3, 10
    s_add_u32 s46, s46, 57344
    v_add_u32 v155, s46, v3
    v_and_b32 v4, 15, v2
    s_waitcnt lgkmcnt(10)
    v_mfma_f32_32x32x16_bf16 v[80:95], v[36:39], v[32:35], v[80:95]
    s_waitcnt lgkmcnt(9)
    v_cmp_gt_u32 vcc, 3, v55
    s_cbranch_vccz P2X17
P2W17:
    ds_read_b32 v55, v1 offset:4
    s_waitcnt lgkmcnt(0)
    v_cmp_gt_u32 vcc, 3, v55
    s_cbranch_vccnz P2W17
P2X17:
    ds_read_b128 v[16:19], v56 offset:49152
    ds_read_b64_tr_b16 v[20:21], v61 offset:49152
    ds_read_b64_tr_b16 v[22:23], v61 offset:49664
    v_lshlrev_b32 v4, 4, v4
    v_lshl_add_u32 v156, v6, 8, v4
    v_add_u32 v156, 1024, v156
    v_and_b32 v4, 27, v2
    s_waitcnt lgkmcnt(9)
    v_mfma_f32_32x32x16_bf16 v[80:95], v[44:47], v[40:43], v[80:95]
    ds_read_b128 v[24:27], v57 offset:49152
    ds_read_b64_tr_b16 v[28:29], v61 offset:51200
    ds_read_b64_tr_b16 v[30:31], v61 offset:51712
    v_xor_b32 v4, 16, v4
    v_min_u32 v4, 1, v4
    v_subrev_u32 v4, 1, v4
    v_and_b32 v157, 0x3f803f80, v4
    s_waitcnt lgkmcnt(9)
    v_mfma_f32_32x32x16_bf16 v[80:95], v[132:135], v[128:131], v[80:95]
    ds_read_b128 v[32:35], v58 offset:49152
    ds_read_b64_tr_b16 v[36:37], v61 offset:53248
    ds_read_b64_tr_b16 v[38:39], v61 offset:53760
    s_mov_b32 s65, 0
    s_waitcnt lgkmcnt(9)
    v_mfma_f32_32x32x16_bf16 v[80:95], v[140:143], v[136:139], v[80:95]
    ds_read_b128 v[40:43], v59 offset:49152
    ds_read_b64_tr_b16 v[44:45], v61 offset:55296
    ds_read_b64_tr_b16 v[46:47], v61 offset:55808
    s_waitcnt lgkmcnt(9)
    v_mfma_f32_32x32x16_bf16 v[80:95], v[20:23], v[16:19], v[80:95]
    ds_read_b128 v[128:131], v56 offset:57344
    ds_read_b64_tr_b16 v[132:133], v61 offset:57344
    ds_read_b64_tr_b16 v[134:135], v61 offset:57856
    s_waitcnt lgkmcnt(9)
    v_mfma_f32_32x32x16_bf16 v[80:95], v[28:31], v[24:27], v[80:95]
    ds_read_b128 v[136:139], v57 offset:57344
    ds_read_b64_tr_b16 v[140:141], v61 offset:59392
    ds_read_b64_tr_b16 v[142:143], v61 offset:59904
    s_waitcnt lgkmcnt(9)
    v_mfma_f32_32x32x16_bf16 v[80:95], v[36:39], v[32:35], v[80:95]
    ds_read_b128 v[16:19], v58 offset:57344
    ds_read_b64_tr_b16 v[20:21], v61 offset:61440
    ds_read_b64_tr_b16 v[22:23], v61 offset:61952
    s_waitcnt lgkmcnt(9)
    v_mfma_f32_32x32x16_bf16 v[80:95], v[44:47], v[40:43], v[80:95]
    ds_read_b128 v[24:27], v59 offset:57344
    ds_read_b64_tr_b16 v[28:29], v61 offset:63488
    ds_read_b64_tr_b16 v[30:31], v61 offset:64000
    s_waitcnt lgkmcnt(9)
    v_mfma_f32_32x32x16_bf16 v[80:95], v[132:135], v[128:131], v[80:95]
    s_waitcnt lgkmcnt(6)
    v_mfma_f32_32x32x16_bf16 v[80:95], v[140:143], v[136:139], v[80:95]
    s_waitcnt lgkmcnt(3)
    v_mfma_f32_32x32x16_bf16 v[80:95], v[20:23], v[16:19], v[80:95]
    v_cvt_pk_bf16_f32 v48, v64, v65
    v_cvt_pk_bf16_f32 v49, v66, v67
    v_cvt_pk_bf16_f32 v50, v68, v69
    v_cvt_pk_bf16_f32 v51, v70, v71
    buffer_store_dwordx4 v[48:51], v7, s[28:31], s56 offen sc1
    s_waitcnt lgkmcnt(0)
    v_mfma_f32_32x32x16_bf16 v[80:95], v[28:31], v[24:27], v[80:95]
    v_cvt_pk_bf16_f32 v160, v72, v73
    v_cvt_pk_bf16_f32 v161, v74, v75
    v_cvt_pk_bf16_f32 v162, v76, v77
    v_cvt_pk_bf16_f32 v163, v78, v79
    buffer_store_dwordx4 v[160:163], v7, s[28:31], s57 offen sc1
    s_mov_b64 exec, 1
    ds_add_u32 v1, v54 offset:148
    s_mov_b64 exec, -1
    s_mov_b32 s58, 0x3eb8aa3b
    s_lshl_b32 s56, s64, 10
    s_add_u32 s56, s56, 0
    s_add_u32 s57, s56, 65536
    s_nop 6
    v_mul_f32 v80, s58, v80
    v_mul_f32 v81, s58, v81
    v_mul_f32 v82, s58, v82
    v_mul_f32 v83, s58, v83
    v_mul_f32 v84, s58, v84
    v_mul_f32 v85, s58, v85
    v_mul_f32 v86, s58, v86
    v_mul_f32 v87, s58, v87
    v_cvt_pk_bf16_f32 v96, v80, v81
    v_cvt_pk_bf16_f32 v97, v82, v83
    v_cvt_pk_bf16_f32 v98, v84, v85
    v_cvt_pk_bf16_f32 v99, v86, v87
    buffer_store_dwordx4 v[96:99], v3, s[28:31], s56 offen sc1
    v_mul_f32 v88, s58, v88
    v_mul_f32 v89, s58, v89
    v_mul_f32 v90, s58, v90
    v_mul_f32 v91, s58, v91
    v_mul_f32 v92, s58, v92
    v_mul_f32 v93, s58, v93
    v_mul_f32 v94, s58, v94
    v_mul_f32 v95, s58, v95
    v_cvt_pk_bf16_f32 v100, v88, v89
    v_cvt_pk_bf16_f32 v101, v90, v91
    v_cvt_pk_bf16_f32 v102, v92, v93
    v_cvt_pk_bf16_f32 v103, v94, v95
    buffer_store_dwordx4 v[100:103], v3, s[28:31], s57 offen sc1
    s_setprio 0
    s_branch WIN1
VPATH:
    s_barrier
    ds_read_b128 v[48:51], v0
    ds_read_b128 v[16:19], v56 offset:0
    ds_read_b64_tr_b16 v[20:21], v60 offset:0
    ds_read_b64_tr_b16 v[22:23], v60 offset:1024
    ds_read_b128 v[24:27], v57 offset:0
    ds_read_b64_tr_b16 v[28:29], v60 offset:4096
    ds_read_b64_tr_b16 v[30:31], v60 offset:5120
    ds_read_b128 v[32:35], v58 offset:0
    ds_read_b64_tr_b16 v[36:37], v60 offset:8192
    ds_read_b64_tr_b16 v[38:39], v60 offset:9216
    ds_read_b128 v[40:43], v59 offset:0
    ds_read_b64_tr_b16 v[44:45], v60 offset:12288
    ds_read_b64_tr_b16 v[46:47], v60 offset:13312
    s_waitcnt lgkmcnt(12)
    buffer_store_dwordx4 v[48:51], v8, s[28:31], s65 offen sc1
    s_waitcnt lgkmcnt(0)
    s_barrier
    ds_read_b128 v[96:99], v56 offset:8192
    ds_read_b64_tr_b16 v[100:101], v60 offset:16384
    ds_read_b64_tr_b16 v[102:103], v60 offset:17408
    ds_read_b128 v[104:107], v57 offset:8192
    ds_read_b64_tr_b16 v[108:109], v60 offset:20480
    ds_read_b64_tr_b16 v[110:111], v60 offset:21504
    ds_read_b128 v[112:115], v58 offset:8192
    ds_read_b64_tr_b16 v[116:117], v60 offset:24576
    ds_read_b64_tr_b16 v[118:119], v60 offset:25600
    ds_read_b128 v[120:123], v59 offset:8192
    ds_read_b64_tr_b16 v[124:125], v60 offset:28672
    ds_read_b64_tr_b16 v[126:127], v60 offset:29696
    v_mfma_f32_32x32x16_bf16 v[64:79], v[16:19], v[20:23], v[64:79]
    v_mfma_f32_32x32x16_bf16 v[64:79], v[24:27], v[28:31], v[64:79]
    v_mfma_f32_32x32x16_bf16 v[64:79], v[32:35], v[36:39], v[64:79]
    v_mfma_f32_32x32x16_bf16 v[64:79], v[40:43], v[44:47], v[64:79]
    s_waitcnt lgkmcnt(0)
    s_barrier
    ds_read_b128 v[16:19], v56 offset:16384
    ds_read_b64_tr_b16 v[20:21], v60 offset:32768
    ds_read_b64_tr_b16 v[22:23], v60 offset:33792
    ds_read_b128 v[24:27], v57 offset:16384
    ds_read_b64_tr_b16 v[28:29], v60 offset:36864
    ds_read_b64_tr_b16 v[30:31], v60 offset:37888
    ds_read_b128 v[32:35], v58 offset:16384
    ds_read_b64_tr_b16 v[36:37], v60 offset:40960
    ds_read_b64_tr_b16 v[38:39], v60 offset:41984
    ds_read_b128 v[40:43], v59 offset:16384
    ds_read_b64_tr_b16 v[44:45], v60 offset:45056
    ds_read_b64_tr_b16 v[46:47], v60 offset:46080
    v_mfma_f32_32x32x16_bf16 v[64:79], v[96:99], v[100:103], v[64:79]
    v_mfma_f32_32x32x16_bf16 v[64:79], v[104:107], v[108:111], v[64:79]
    v_mfma_f32_32x32x16_bf16 v[64:79], v[112:115], v[116:119], v[64:79]
    v_mfma_f32_32x32x16_bf16 v[64:79], v[120:123], v[124:127], v[64:79]
    s_waitcnt lgkmcnt(0)
    s_barrier
    ds_read_b128 v[96:99], v56 offset:24576
    ds_read_b64_tr_b16 v[100:101], v60 offset:49152
    ds_read_b64_tr_b16 v[102:103], v60 offset:50176
    ds_read_b128 v[104:107], v57 offset:24576
    ds_read_b64_tr_b16 v[108:109], v60 offset:53248
    ds_read_b64_tr_b16 v[110:111], v60 offset:54272
    ds_read_b128 v[112:115], v58 offset:24576
    ds_read_b64_tr_b16 v[116:117], v60 offset:57344
    ds_read_b64_tr_b16 v[118:119], v60 offset:58368
    ds_read_b128 v[120:123], v59 offset:24576
    ds_read_b64_tr_b16 v[124:125], v60 offset:61440
    ds_read_b64_tr_b16 v[126:127], v60 offset:62464
    v_mfma_f32_32x32x16_bf16 v[64:79], v[16:19], v[20:23], v[64:79]
    v_mfma_f32_32x32x16_bf16 v[64:79], v[24:27], v[28:31], v[64:79]
    v_mfma_f32_32x32x16_bf16 v[64:79], v[32:35], v[36:39], v[64:79]
    v_mfma_f32_32x32x16_bf16 v[64:79], v[40:43], v[44:47], v[64:79]
    s_waitcnt lgkmcnt(0)
    s_waitcnt vmcnt(0)
    s_barrier
    ds_read_b128 v[16:19], v56 offset:32768
    ds_read_b64_tr_b16 v[20:21], v60 offset:0
    ds_read_b64_tr_b16 v[22:23], v60 offset:1024
    ds_read_b128 v[24:27], v57 offset:32768
    ds_read_b64_tr_b16 v[28:29], v60 offset:4096
    ds_read_b64_tr_b16 v[30:31], v60 offset:5120
    ds_read_b128 v[32:35], v58 offset:32768
    ds_read_b64_tr_b16 v[36:37], v60 offset:8192
    ds_read_b64_tr_b16 v[38:39], v60 offset:9216
    ds_read_b128 v[40:43], v59 offset:32768
    ds_read_b64_tr_b16 v[44:45], v60 offset:12288
    ds_read_b64_tr_b16 v[46:47], v60 offset:13312
    v_mfma_f32_32x32x16_bf16 v[64:79], v[96:99], v[100:103], v[64:79]
    v_mfma_f32_32x32x16_bf16 v[64:79], v[104:107], v[108:111], v[64:79]
    v_mfma_f32_32x32x16_bf16 v[64:79], v[112:115], v[116:119], v[64:79]
    v_mfma_f32_32x32x16_bf16 v[64:79], v[120:123], v[124:127], v[64:79]
    s_waitcnt lgkmcnt(0)
    s_barrier
    ds_read_b128 v[96:99], v56 offset:40960
    ds_read_b64_tr_b16 v[100:101], v60 offset:16384
    ds_read_b64_tr_b16 v[102:103], v60 offset:17408
    ds_read_b128 v[104:107], v57 offset:40960
    ds_read_b64_tr_b16 v[108:109], v60 offset:20480
    ds_read_b64_tr_b16 v[110:111], v60 offset:21504
    ds_read_b128 v[112:115], v58 offset:40960
    ds_read_b64_tr_b16 v[116:117], v60 offset:24576
    ds_read_b64_tr_b16 v[118:119], v60 offset:25600
    ds_read_b128 v[120:123], v59 offset:40960
    ds_read_b64_tr_b16 v[124:125], v60 offset:28672
    ds_read_b64_tr_b16 v[126:127], v60 offset:29696
    v_mfma_f32_32x32x16_bf16 v[64:79], v[16:19], v[20:23], v[64:79]
    v_mfma_f32_32x32x16_bf16 v[64:79], v[24:27], v[28:31], v[64:79]
    v_mfma_f32_32x32x16_bf16 v[64:79], v[32:35], v[36:39], v[64:79]
    v_mfma_f32_32x32x16_bf16 v[64:79], v[40:43], v[44:47], v[64:79]
    s_waitcnt lgkmcnt(0)
    s_barrier
    ds_read_b128 v[16:19], v56 offset:49152
    ds_read_b64_tr_b16 v[20:21], v60 offset:32768
    ds_read_b64_tr_b16 v[22:23], v60 offset:33792
    ds_read_b128 v[24:27], v57 offset:49152
    ds_read_b64_tr_b16 v[28:29], v60 offset:36864
    ds_read_b64_tr_b16 v[30:31], v60 offset:37888
    ds_read_b128 v[32:35], v58 offset:49152
    ds_read_b64_tr_b16 v[36:37], v60 offset:40960
    ds_read_b64_tr_b16 v[38:39], v60 offset:41984
    ds_read_b128 v[40:43], v59 offset:49152
    ds_read_b64_tr_b16 v[44:45], v60 offset:45056
    ds_read_b64_tr_b16 v[46:47], v60 offset:46080
    v_mfma_f32_32x32x16_bf16 v[64:79], v[96:99], v[100:103], v[64:79]
    v_mfma_f32_32x32x16_bf16 v[64:79], v[104:107], v[108:111], v[64:79]
    v_mfma_f32_32x32x16_bf16 v[64:79], v[112:115], v[116:119], v[64:79]
    v_mfma_f32_32x32x16_bf16 v[64:79], v[120:123], v[124:127], v[64:79]
    s_waitcnt lgkmcnt(0)
    s_barrier
    ds_read_b128 v[96:99], v56 offset:57344
    ds_read_b64_tr_b16 v[100:101], v60 offset:49152
    ds_read_b64_tr_b16 v[102:103], v60 offset:50176
    ds_read_b128 v[104:107], v57 offset:57344
    ds_read_b64_tr_b16 v[108:109], v60 offset:53248
    ds_read_b64_tr_b16 v[110:111], v60 offset:54272
    ds_read_b128 v[112:115], v58 offset:57344
    ds_read_b64_tr_b16 v[116:117], v60 offset:57344
    ds_read_b64_tr_b16 v[118:119], v60 offset:58368
    ds_read_b128 v[120:123], v59 offset:57344
    ds_read_b64_tr_b16 v[124:125], v60 offset:61440
    ds_read_b64_tr_b16 v[126:127], v60 offset:62464
    v_mfma_f32_32x32x16_bf16 v[64:79], v[16:19], v[20:23], v[64:79]
    v_mfma_f32_32x32x16_bf16 v[64:79], v[24:27], v[28:31], v[64:79]
    v_mfma_f32_32x32x16_bf16 v[64:79], v[32:35], v[36:39], v[64:79]
    v_mfma_f32_32x32x16_bf16 v[64:79], v[40:43], v[44:47], v[64:79]
    s_waitcnt lgkmcnt(0)
    s_barrier
    v_mfma_f32_32x32x16_bf16 v[64:79], v[96:99], v[100:103], v[64:79]
    v_mfma_f32_32x32x16_bf16 v[64:79], v[104:107], v[108:111], v[64:79]
    v_mfma_f32_32x32x16_bf16 v[64:79], v[112:115], v[116:119], v[64:79]
    v_mfma_f32_32x32x16_bf16 v[64:79], v[120:123], v[124:127], v[64:79]
    s_nop 7
LW18:
    ds_read_b32 v55, v1 offset:8
    s_waitcnt lgkmcnt(0)
    v_cmp_gt_u32 vcc, 1, v55
    s_cbranch_vccnz LW18
LWX18:
    v_cvt_pk_bf16_f32 v16, v64, v65
    v_cvt_pk_bf16_f32 v17, v66, v67
    v_cvt_pk_bf16_f32 v18, v68, v69
    v_cvt_pk_bf16_f32 v19, v70, v71
    buffer_store_dwordx4 v[16:19], v9, s[28:31], s56 offen offset:1024 sc1
    v_cvt_pk_bf16_f32 v20, v72, v73
    v_cvt_pk_bf16_f32 v21, v74, v75
    v_cvt_pk_bf16_f32 v22, v76, v77
    v_cvt_pk_bf16_f32 v23, v78, v79
    buffer_store_dwordx4 v[20:23], v9, s[28:31], s56 offen offset:1536 sc1
    s_lshr_b32 s40, s3, 2
    s_and_b32 s41, s3, 3
    v_and_b32 v6, 1, v2
    v_and_b32 v4, 15, v2
    v_lshrrev_b32 v5, 4, v2
    v_mul_u32_u24 v6, 4162, v6
    v_sub_u32 v6, 150628, v6
    v_lshl_add_u32 v6, v4, 1, v6
    v_lshl_add_u32 v6, v5, 4, v6
    s_mul_i32 s45, s40, 8324
    s_lshl_b32 s46, s41, 7
    s_add_u32 s45, s45, s46
    v_add_u32 v144, s45, v6
    v_add_u32 v145, 1024, v144
    v_add_u32 v146, 2048, v144
    v_add_u32 v147, 3072, v144
    v_lshlrev_b32 v6, 1, v4
    v_sub_u32 v6, v5, v6
    v_lshlrev_b32 v6, 4, v6
    s_mul_i32 s47, s40, 7680
    s_add_u32 s46, s47, s46
    s_add_u32 s46, s46, 131552
    v_add_u32 v148, s46, v6
    v_mov_b32 v0, 1
    s_lshl_b32 s46, s40, 2
    v_add_u32 v149, s46, v1
    s_lshl_b32 s46, s3, 13
    s_add_u32 s46, s46, 65536
    v_bfe_u32 v6, v2, 5, 1
    v_lshlrev_b32 v6, 7, v6
    v_xor_b32 v151, v3, v6
    v_add_u32 v151, s46, v151
    v_bfe_u32 v152, v2, 1, 4
    v_and_b32 v6, 1, v2
    v_lshlrev_b32 v4, 3, v6
    v_xor_b32 v152, v152, v4
    v_lshl_add_u32 v152, v6, 5, v152
    v_lshlrev_b32 v152, 4, v152
    v_lshrrev_b32 v6, 5, v2
    v_lshl_add_u32 v152, v6, 10, v152
    s_lshl_b32 s46, s41, 11
    s_lshl_b32 s45, s40, 15
    s_add_u32 s46, s46, s45
    s_add_u32 s46, s46, 65536
    v_add_u32 v152, s46, v152
    s_lshl_b32 s46, s41, 6
    s_sub_u32 s46, 255, s46
    v_sub_u32 v153, s46, v2
    v_lshlrev_b32 v153, 4, v153
    s_add_u32 s47, s47, 131072
    v_add_u32 v153, s47, v153
    s_lshl_b32 s46, s40, 4
    s_lshr_b32 s43, s68, s46
    s_lshl_b32 s43, s43, 16
    s_lshl_b32 s42, s66, 1
    s_add_u32 s42, s42, s40
    s_lshl_b32 s42, s42, 12
    s_lshl_b32 s46, s41, 10
    s_add_u32 s42, s42, s46
    s_add_u32 s42, s42, 10485760
    s_lshl_b32 s55, s50, 3
    s_add_u32 s55, s55, s3
    s_lshl_b32 s55, s55, 14
    s_add_u32 s55, s55, 13631488
    v_lshrrev_b32 v154, 3, v2
    v_and_b32 v4, 7, v2
    v_lshlrev_b32 v154, 10, v154
    v_lshl_add_u32 v154, v4, 4, v154
    s_lshl_b32 s44, s49, 16
    s_lshl_b32 s46, s3, 13
    s_add_u32 s44, s44, s46
    s_lshl_b32 s46, s48, 7
    s_add_u32 s44, s44, s46
    s_mov_b32 s66, 0xffff
    s_mov_b32 s67, 0xffff
    s_mov_b32 s68, 0
    s_lshl_b32 s46, s3, 10
    s_add_u32 s46, s46, 57344
    v_add_u32 v155, s46, v3
    v_and_b32 v4, 15, v2
    v_lshlrev_b32 v4, 4, v4
    v_lshl_add_u32 v156, v6, 8, v4
    v_add_u32 v156, 1024, v156
    v_and_b32 v4, 27, v2
    v_xor_b32 v4, 16, v4
    v_min_u32 v4, 1, v4
    v_subrev_u32 v4, 1, v4
    v_and_b32 v157, 0x3f803f80, v4
    s_mov_b32 s65, 0
WIN1:
    s_mov_b32 s63, 0
CVW:
    s_getreg_b32 s57, hwreg(HW_REG_IB_STS, 0, 4)
    s_or_b32 s57, s57, s63
    s_cbranch_scc1 TS19
    s_waitcnt vmcnt(0)
    s_mov_b64 exec, 1
    ds_add_u32 v1, v0 offset:152
    s_mov_b64 exec, -1
    s_mov_b32 s63, 1
TS19:
    ds_read_b32 v150, v149 offset:176
    s_waitcnt lgkmcnt(0)
    v_cmp_gt_u32 vcc, 2, v150
    s_cbranch_vccnz CVW
    ds_read2_b32 v[104:105], v144 offset0:0 offset1:1
    ds_read2_b32 v[106:107], v144 offset0:2 offset1:3
    ds_read_b128 v[48:51], v148 offset:3584
    ds_read_b128 v[52:55], v148 offset:3072
    ds_read_b128 v[56:59], v148 offset:2560
    ds_read_b128 v[60:63], v148 offset:2048
    ds_read_b128 v[32:35], v148 offset:1536
    ds_read_b128 v[36:39], v148 offset:1024
    ds_read_b128 v[40:43], v148 offset:512
    ds_read_b128 v[44:47], v148 offset:0
    ds_read2_b32 v[108:109], v144 offset0:128 offset1:129
    ds_read2_b32 v[110:111], v144 offset0:130 offset1:131
    ds_read2_b32 v[112:113], v145 offset0:0 offset1:1
    ds_read2_b32 v[114:115], v145 offset0:2 offset1:3
    s_waitcnt lgkmcnt(12)
    s_waitcnt lgkmcnt(11)
    v_mfma_f32_16x16x32_bf16 v[64:67], v[104:107], v[48:51], 0
    v_mov_b32 v12, v157
    s_waitcnt lgkmcnt(10)
    v_mfma_f32_16x16x32_bf16 v[68:71], v[104:107], v[52:55], 0
    v_mov_b32 v13, v157
    s_waitcnt lgkmcnt(9)
    v_mfma_f32_16x16x32_bf16 v[72:75], v[104:107], v[56:59], 0
    v_mov_b32 v14, v157
    s_waitcnt lgkmcnt(8)
    v_mfma_f32_16x16x32_bf16 v[76:79], v[104:107], v[60:63], 0
    v_mov_b32 v15, v157
    s_waitcnt lgkmcnt(7)
    v_mfma_f32_16x16x32_bf16 v[80:83], v[104:107], v[32:35], 0
    v_mov_b32 v16, v157
    s_waitcnt lgkmcnt(6)
    v_mfma_f32_16x16x32_bf16 v[84:87], v[104:107], v[36:39], 0
    v_mov_b32 v17, v157
    s_waitcnt lgkmcnt(5)
    v_mfma_f32_16x16x32_bf16 v[88:91], v[104:107], v[40:43], 0
    v_mov_b32 v18, v157
    s_waitcnt lgkmcnt(4)
    v_mfma_f32_16x16x32_bf16 v[92:95], v[104:107], v[44:47], 0
    v_mov_b32 v19, v157
    ds_read2_b32 v[116:117], v145 offset0:128 offset1:129
    ds_read2_b32 v[118:119], v145 offset0:130 offset1:131
    ds_read_b128 v[44:47], v148 offset:64
    s_getreg_b32 s57, hwreg(HW_REG_IB_STS, 0, 4)
    s_or_b32 s57, s57, s63
    s_cbranch_scc1 TS20
    s_waitcnt vmcnt(0)
    s_mov_b64 exec, 1
    ds_add_u32 v1, v0 offset:152
    s_mov_b64 exec, -1
    s_mov_b32 s63, 1
TS20:
    s_waitcnt lgkmcnt(5)
    v_mfma_f32_16x16x32_bf16 v[68:71], v[108:111], v[48:51], v[68:71]
    v_mov_b32 v20, v157
    v_mfma_f32_16x16x32_bf16 v[72:75], v[108:111], v[52:55], v[72:75]
    v_mov_b32 v21, v157
    v_mfma_f32_16x16x32_bf16 v[76:79], v[108:111], v[56:59], v[76:79]
    v_mov_b32 v22, v157
    v_mfma_f32_16x16x32_bf16 v[80:83], v[108:111], v[60:63], v[80:83]
    v_mov_b32 v23, v157
    v_mfma_f32_16x16x32_bf16 v[84:87], v[108:111], v[32:35], v[84:87]
    v_mov_b32 v24, v157
    v_mfma_f32_16x16x32_bf16 v[88:91], v[108:111], v[36:39], v[88:91]
    v_mov_b32 v25, v157
    v_mfma_f32_16x16x32_bf16 v[92:95], v[108:111], v[40:43], v[92:95]
    v_mov_b32 v26, v157
    ds_read2_b32 v[120:121], v146 offset0:0 offset1:1
    ds_read2_b32 v[122:123], v146 offset0:2 offset1:3
    ds_read_b128 v[40:43], v148 offset:576
    s_getreg_b32 s57, hwreg(HW_REG_IB_STS, 0, 4)
    s_or_b32 s57, s57, s63
    s_cbranch_scc1 TS21
    s_waitcnt vmcnt(0)
    s_mov_b64 exec, 1
    ds_add_u32 v1, v0 offset:152
    s_mov_b64 exec, -1
    s_mov_b32 s63, 1
TS21:
    s_waitcnt lgkmcnt(6)
    v_mfma_f32_16x16x32_bf16 v[72:75], v[112:115], v[48:51], v[72:75]
    v_mov_b32 v27, v157
    v_mfma_f32_16x16x32_bf16 v[76:79], v[112:115], v[52:55], v[76:79]
    v_mov_b32 v28, 0xdddd
    v_mfma_f32_16x16x32_bf16 v[80:83], v[112:115], v[56:59], v[80:83]
    v_mov_b32 v29, v3
    v_mfma_f32_16x16x32_bf16 v[84:87], v[112:115], v[60:63], v[84:87]
    v_mov_b32 v30, v156
    v_mfma_f32_16x16x32_bf16 v[88:91], v[112:115], v[32:35], v[88:91]
    v_mfma_f32_16x16x32_bf16 v[92:95], v[112:115], v[36:39], v[92:95]
    ds_read2_b32 v[124:125], v146 offset0:128 offset1:129
    ds_read2_b32 v[126:127], v146 offset0:130 offset1:131
    ds_read_b128 v[36:39], v148 offset:1088
    s_getreg_b32 s57, hwreg(HW_REG_IB_STS, 0, 4)
    s_or_b32 s57, s57, s63
    s_cbranch_scc1 TS22
    s_waitcnt vmcnt(0)
    s_mov_b64 exec, 1
    ds_add_u32 v1, v0 offset:152
    s_mov_b64 exec, -1
    s_mov_b32 s63, 1
TS22:
    s_waitcnt lgkmcnt(7)
    v_mfma_f32_16x16x32_bf16 v[76:79], v[116:119], v[48:51], v[76:79]
    v_mfma_f32_16x16x32_bf16 v[80:83], v[116:119], v[52:55], v[80:83]
    v_mfma_f32_16x16x32_bf16 v[84:87], v[116:119], v[56:59], v[84:87]
    v_mfma_f32_16x16x32_bf16 v[88:91], v[116:119], v[60:63], v[88:91]
    v_mfma_f32_16x16x32_bf16 v[92:95], v[116:119], v[32:35], v[92:95]
    ds_read2_b32 v[128:129], v147 offset0:0 offset1:1
    ds_read2_b32 v[130:131], v147 offset0:2 offset1:3
    ds_read_b128 v[32:35], v148 offset:1600
    s_getreg_b32 s57, hwreg(HW_REG_IB_STS, 0, 4)
    s_or_b32 s57, s57, s63
    s_cbranch_scc1 TS23
    s_waitcnt vmcnt(0)
    s_mov_b64 exec, 1
    ds_add_u32 v1, v0 offset:152
    s_mov_b64 exec, -1
    s_mov_b32 s63, 1
TS23:
    s_waitcnt lgkmcnt(7)
    v_mfma_f32_16x16x32_bf16 v[80:83], v[120:123], v[48:51], v[80:83]
    v_mfma_f32_16x16x32_bf16 v[84:87], v[120:123], v[52:55], v[84:87]
    v_mfma_f32_16x16x32_bf16 v[88:91], v[120:123], v[56:59], v[88:91]
    v_mfma_f32_16x16x32_bf16 v[92:95], v[120:123], v[60:63], v[92:95]
    ds_read2_b32 v[132:133], v147 offset0:128 offset1:129
    ds_read2_b32 v[134:135], v147 offset0:130 offset1:131
    ds_read_b128 v[60:63], v148 offset:2112
    ds_read_b32 v150, v1 offset:148
    s_waitcnt lgkmcnt(8)
    v_mfma_f32_16x16x32_bf16 v[84:87], v[124:127], v[48:51], v[84:87]
    v_mfma_f32_16x16x32_bf16 v[88:91], v[124:127], v[52:55], v[88:91]
    v_mfma_f32_16x16x32_bf16 v[92:95], v[124:127], v[56:59], v[92:95]
    ds_read_b128 v[56:59], v148 offset:2624
    ds_read2_b32 v[104:105], v144 offset0:16 offset1:17
    ds_read2_b32 v[106:107], v144 offset0:18 offset1:19
    s_getreg_b32 s57, hwreg(HW_REG_IB_STS, 0, 4)
    s_or_b32 s57, s57, s63
    s_cbranch_scc1 TS24
    s_waitcnt vmcnt(0)
    s_mov_b64 exec, 1
    ds_add_u32 v1, v0 offset:152
    s_mov_b64 exec, -1
    s_mov_b32 s63, 1
TS24:
    s_waitcnt lgkmcnt(8)
    v_mfma_f32_16x16x32_bf16 v[88:91], v[128:131], v[48:51], v[88:91]
    v_mfma_f32_16x16x32_bf16 v[92:95], v[128:131], v[52:55], v[92:95]
    ds_read_b128 v[52:55], v148 offset:3136
    ds_read2_b32 v[108:109], v144 offset0:144 offset1:145
    ds_read2_b32 v[110:111], v144 offset0:146 offset1:147
    s_waitcnt lgkmcnt(8)
    v_mfma_f32_16x16x32_bf16 v[92:95], v[132:135], v[48:51], v[92:95]
    ds_read_b128 v[48:51], v148 offset:3648
    ds_read2_b32 v[112:113], v145 offset0:16 offset1:17
    ds_read2_b32 v[114:115], v145 offset0:18 offset1:19
    s_waitcnt lgkmcnt(9)
    v_cmp_gt_u32 vcc, 4, v150
    s_cbranch_vccz LWX25
LW25:
    ds_read_b32 v150, v1 offset:148
    s_waitcnt lgkmcnt(0)
    v_cmp_gt_u32 vcc, 4, v150
    s_cbranch_vccnz LW25
LWX25:
    s_waitcnt lgkmcnt(6)
    v_mfma_f32_16x16x32_bf16 v[92:95], v[104:107], v[44:47], v[92:95]
    v_mfma_f32_16x16x32_bf16 v[88:91], v[104:107], v[40:43], v[88:91]
    v_mfma_f32_16x16x32_bf16 v[84:87], v[104:107], v[36:39], v[84:87]
    v_mfma_f32_16x16x32_bf16 v[80:83], v[104:107], v[32:35], v[80:83]
    v_mfma_f32_16x16x32_bf16 v[76:79], v[104:107], v[60:63], v[76:79]
    v_mfma_f32_16x16x32_bf16 v[72:75], v[104:107], v[56:59], v[72:75]
    s_waitcnt lgkmcnt(5)
    v_mfma_f32_16x16x32_bf16 v[68:71], v[104:107], v[52:55], v[68:71]
    s_waitcnt lgkmcnt(2)
    v_mfma_f32_16x16x32_bf16 v[64:67], v[104:107], v[48:51], v[64:67]
    ds_read2_b32 v[116:117], v145 offset0:144 offset1:145
    ds_read2_b32 v[118:119], v145 offset0:146 offset1:147
    s_getreg_b32 s57, hwreg(HW_REG_IB_STS, 0, 4)
    s_or_b32 s57, s57, s63
    s_cbranch_scc1 TS26
    s_waitcnt vmcnt(0)
    s_mov_b64 exec, 1
    ds_add_u32 v1, v0 offset:152
    s_mov_b64 exec, -1
    s_mov_b32 s63, 1
TS26:
    v_mfma_f32_16x16x32_bf16 v[68:71], v[108:111], v[48:51], v[68:71]
    v_mfma_f32_16x16x32_bf16 v[72:75], v[108:111], v[52:55], v[72:75]
    v_mfma_f32_16x16x32_bf16 v[76:79], v[108:111], v[56:59], v[76:79]
    v_mfma_f32_16x16x32_bf16 v[80:83], v[108:111], v[60:63], v[80:83]
    v_mfma_f32_16x16x32_bf16 v[84:87], v[108:111], v[32:35], v[84:87]
    v_mfma_f32_16x16x32_bf16 v[88:91], v[108:111], v[36:39], v[88:91]
    v_mfma_f32_16x16x32_bf16 v[92:95], v[108:111], v[40:43], v[92:95]
    ds_read2_b32 v[120:121], v146 offset0:16 offset1:17
    ds_read2_b32 v[122:123], v146 offset0:18 offset1:19
    ds_read_b128 v[136:139], v153
    s_getreg_b32 s57, hwreg(HW_REG_IB_STS, 0, 4)
    s_or_b32 s57, s57, s63
    s_cbranch_scc1 TS27
    s_waitcnt vmcnt(0)
    s_mov_b64 exec, 1
    ds_add_u32 v1, v0 offset:152
    s_mov_b64 exec, -1
    s_mov_b32 s63, 1
TS27:
    s_waitcnt lgkmcnt(5)
    v_mfma_f32_16x16x32_bf16 v[72:75], v[112:115], v[48:51], v[72:75]
    v_mfma_f32_16x16x32_bf16 v[76:79], v[112:115], v[52:55], v[76:79]
    v_mfma_f32_16x16x32_bf16 v[80:83], v[112:115], v[56:59], v[80:83]
    v_mfma_f32_16x16x32_bf16 v[84:87], v[112:115], v[60:63], v[84:87]
    v_mfma_f32_16x16x32_bf16 v[88:91], v[112:115], v[32:35], v[88:91]
    v_mfma_f32_16x16x32_bf16 v[92:95], v[112:115], v[36:39], v[92:95]
    ds_read2_b32 v[124:125], v146 offset0:144 offset1:145
    ds_read2_b32 v[126:127], v146 offset0:146 offset1:147
    ds_write_b128 v151, v[64:67] offset:0
    ds_write_b128 v151, v[68:71] offset:1024
    s_getreg_b32 s57, hwreg(HW_REG_IB_STS, 0, 4)
    s_or_b32 s57, s57, s63
    s_cbranch_scc1 TS28
    s_waitcnt vmcnt(0)
    s_mov_b64 exec, 1
    ds_add_u32 v1, v0 offset:152
    s_mov_b64 exec, -1
    s_mov_b32 s63, 1
TS28:
    s_waitcnt lgkmcnt(7)
    v_mfma_f32_16x16x32_bf16 v[76:79], v[116:119], v[48:51], v[76:79]
    v_mfma_f32_16x16x32_bf16 v[80:83], v[116:119], v[52:55], v[80:83]
    v_mfma_f32_16x16x32_bf16 v[84:87], v[116:119], v[56:59], v[84:87]
    v_mfma_f32_16x16x32_bf16 v[88:91], v[116:119], v[60:63], v[88:91]
    v_mfma_f32_16x16x32_bf16 v[92:95], v[116:119], v[32:35], v[92:95]
    ds_read2_b32 v[128:129], v147 offset0:16 offset1:17
    ds_read2_b32 v[130:131], v147 offset0:18 offset1:19
    ds_write_b128 v151, v[72:75] offset:2048
    s_waitcnt lgkmcnt(8)
    v_mfma_f32_16x16x32_bf16 v[80:83], v[120:123], v[48:51], v[80:83]
    v_mfma_f32_16x16x32_bf16 v[84:87], v[120:123], v[52:55], v[84:87]
    v_mfma_f32_16x16x32_bf16 v[88:91], v[120:123], v[56:59], v[88:91]
    v_mfma_f32_16x16x32_bf16 v[92:95], v[120:123], v[60:63], v[92:95]
    ds_read2_b32 v[132:133], v147 offset0:144 offset1:145
    ds_read2_b32 v[134:135], v147 offset0:146 offset1:147
    ds_write_b128 v151, v[76:79] offset:3072
    s_getreg_b32 s57, hwreg(HW_REG_IB_STS, 0, 4)
    s_or_b32 s57, s57, s63
    s_cbranch_scc1 TS29
    s_waitcnt vmcnt(0)
    s_mov_b64 exec, 1
    ds_add_u32 v1, v0 offset:152
    s_mov_b64 exec, -1
    s_mov_b32 s63, 1
TS29:
    s_waitcnt lgkmcnt(8)
    v_mfma_f32_16x16x32_bf16 v[84:87], v[124:127], v[48:51], v[84:87]
    v_mfma_f32_16x16x32_bf16 v[88:91], v[124:127], v[52:55], v[88:91]
    v_mfma_f32_16x16x32_bf16 v[92:95], v[124:127], v[56:59], v[92:95]
    s_waitcnt lgkmcnt(4)
    v_mfma_f32_16x16x32_bf16 v[88:91], v[128:131], v[48:51], v[88:91]
    v_mfma_f32_16x16x32_bf16 v[92:95], v[128:131], v[52:55], v[92:95]
    s_waitcnt lgkmcnt(1)
    v_mfma_f32_16x16x32_bf16 v[92:95], v[132:135], v[48:51], v[92:95]
    v_lshlrev_b32 v11, 16, v136
    v_and_b32 v10, s59, v136
    v_lshlrev_b32 v9, 16, v137
    v_and_b32 v8, s59, v137
    ds_write_b128 v151, v[80:83] offset:4096
    ds_write_b128 v151, v[84:87] offset:5120
    v_lshlrev_b32 v7, 16, v138
    v_and_b32 v6, s59, v138
    v_lshlrev_b32 v5, 16, v139
    v_and_b32 v4, s59, v139
    ds_write_b128 v151, v[88:91] offset:6144
    ds_write_b128 v151, v[92:95] offset:7168
    v_mov_b32 v56, 0
    v_mov_b32 v57, 0
    v_mov_b32 v58, 0
    v_mov_b32 v59, 0
    v_mov_b32 v60, 0
    v_mov_b32 v61, 0
    v_mov_b32 v62, 0
    v_mov_b32 v63, 0
    s_waitcnt lgkmcnt(0)
    s_mov_b64 exec, 1
    ds_add_u32 v149, v0 offset:120
    s_mov_b64 exec, -1
    v_mov_b32 v64, 0
    v_mov_b32 v65, 0
    v_mov_b32 v66, 0
    v_mov_b32 v67, 0
    v_mov_b32 v68, 0
    v_mov_b32 v69, 0
    v_mov_b32 v70, 0
    v_mov_b32 v71, 0
    v_mov_b32 v72, 0
    v_mov_b32 v73, 0
    v_mov_b32 v74, 0
    v_mov_b32 v75, 0
    v_mov_b32 v76, 0
    v_mov_b32 v77, 0
    v_mov_b32 v78, 0
    v_mov_b32 v79, 0
    s_cmp_lg_u32 s63, 0
    s_cbranch_scc1 TS30
    s_waitcnt vmcnt(0)
    s_mov_b64 exec, 1
    ds_add_u32 v1, v0 offset:152
    s_mov_b64 exec, -1
    s_mov_b32 s63, 1
TS30:
LW31:
    ds_read_b32 v150, v149 offset:120
    s_waitcnt lgkmcnt(0)
    v_cmp_gt_u32 vcc, 4, v150
    s_cbranch_vccnz LW31
LWX31:
    ds_read_b128 v[104:107], v152 offset:0
    ds_read_b128 v[108:111], v152 offset:256
    ds_read_b128 v[112:115], v152 offset:8192
    ds_read_b128 v[116:119], v152 offset:8448
    ds_read_b128 v[120:123], v152 offset:16384
    ds_read_b128 v[124:127], v152 offset:16640
    ds_read_b128 v[128:131], v152 offset:24576
    ds_read_b128 v[132:135], v152 offset:24832
    s_waitcnt lgkmcnt(6)
    v_fmac_f32 v104, s43, v4
    v_fmac_f32 v105, s43, v5
    v_fmac_f32 v106, s43, v6
    v_fmac_f32 v107, s43, v7
    v_fmac_f32 v108, s43, v8
    v_fmac_f32 v109, s43, v9
    v_fmac_f32 v110, s43, v10
    v_fmac_f32 v111, s43, v11
    s_waitcnt lgkmcnt(4)
    v_add_f32 v104, v104, v112
    v_add_f32 v105, v105, v113
    v_add_f32 v106, v106, v114
    v_add_f32 v107, v107, v115
    v_add_f32 v108, v108, v116
    v_add_f32 v109, v109, v117
    v_add_f32 v110, v110, v118
    v_add_f32 v111, v111, v119
    s_waitcnt lgkmcnt(2)
    v_add_f32 v104, v104, v120
    v_add_f32 v105, v105, v121
    v_add_f32 v106, v106, v122
    v_add_f32 v107, v107, v123
    v_add_f32 v108, v108, v124
    v_add_f32 v109, v109, v125
    v_add_f32 v110, v110, v126
    v_add_f32 v111, v111, v127
    s_waitcnt lgkmcnt(0)
    v_add_f32 v104, v104, v128
    v_add_f32 v105, v105, v129
    v_add_f32 v106, v106, v130
    v_add_f32 v107, v107, v131
    v_add_f32 v108, v108, v132
    v_add_f32 v109, v109, v133
    v_add_f32 v110, v110, v134
    v_add_f32 v111, v111, v135
    v_cvt_pk_bf16_f32 v100, v104, v105
    v_cvt_pk_bf16_f32 v101, v106, v107
    v_cvt_pk_bf16_f32 v102, v108, v109
    v_cvt_pk_bf16_f32 v103, v110, v111
    buffer_store_dwordx4 v[100:103], v3, s[28:31], s42 offen sc1
RUN1:
    s_barrier
    ds_read_b128 v[4:7], v155
    s_mov_b64 exec, 1
    ds_add_u32 v1, v0 offset:192
    s_mov_b64 exec, -1
    ds_read_b128 v[8:11], v3
    s_mov_b64 exec, s[66:67]
    ds_read_b128 v[12:15], v30
    ds_read_b128 v[16:19], v30 offset:512
    ds_read_b128 v[24:27], v30 offset:512
    s_mov_b64 exec, -1
    s_waitcnt lgkmcnt(3)
    v_mfma_f32_32x32x16_bf16 v[32:47], v[8:11], v[4:7], 0
    ds_read_b128 v[8:11], v29 offset:2048
    s_waitcnt lgkmcnt(1)
    s_nop 9
.p2align 6
    s_setprio 3
    v_exp_f32 v32, v32
    v_exp_f32 v33, v33
    v_smfmac_f32_32x32x32_bf16 v[64:79], v[24:27], v[56:63], v28
    s_mov_b64 exec, s[66:67]
    ds_read_b128 v[20:23], v30 offset:2048
    ds_read_b128 v[24:27], v30 offset:2560
    s_mov_b64 exec, -1
    v_exp_f32 v34, v34
    v_exp_f32 v35, v35
    v_exp_f32 v36, v36
    s_waitcnt lgkmcnt(2)
    v_mfma_f32_32x32x16_bf16 v[48:63], v[8:11], v[4:7], 0
    ds_read_b128 v[8:11], v29 offset:4096
    v_exp_f32 v37, v37
    v_exp_f32 v38, v38
    v_exp_f32 v39, v39
    v_exp_f32 v40, v40
    v_exp_f32 v41, v41
    v_smfmac_f32_32x32x32_bf16 v[64:79], v[12:15], v[32:39], v28
    v_exp_f32 v42, v42
    v_exp_f32 v43, v43
    v_exp_f32 v44, v44
    v_exp_f32 v45, v45
    v_exp_f32 v46, v46
    v_exp_f32 v47, v47
    s_setprio 2
    v_exp_f32 v48, v48
    v_exp_f32 v49, v49
    v_smfmac_f32_32x32x32_bf16 v[64:79], v[16:19], v[40:47], v28
    s_mov_b64 exec, s[66:67]
    ds_read_b128 v[12:15], v30 offset:4096
    ds_read_b128 v[16:19], v30 offset:4608
    s_mov_b64 exec, -1
    v_exp_f32 v50, v50
    v_exp_f32 v51, v51
    v_exp_f32 v52, v52
    s_waitcnt lgkmcnt(2)
    v_mfma_f32_32x32x16_bf16 v[32:47], v[8:11], v[4:7], 0
    ds_read_b128 v[8:11], v29 offset:6144
    v_exp_f32 v53, v53
    v_exp_f32 v54, v54
    v_exp_f32 v55, v55
    v_exp_f32 v56, v56
    v_exp_f32 v57, v57
    v_smfmac_f32_32x32x32_bf16 v[64:79], v[20:23], v[48:55], v28
    v_exp_f32 v58, v58
    v_exp_f32 v59, v59
    v_exp_f32 v60, v60
    v_exp_f32 v61, v61
    v_exp_f32 v62, v62
    v_exp_f32 v63, v63
    s_setprio 1
    v_exp_f32 v32, v32
    v_exp_f32 v33, v33
    v_smfmac_f32_32x32x32_bf16 v[64:79], v[24:27], v[56:63], v28
    s_mov_b64 exec, s[66:67]
    ds_read_b128 v[20:23], v30 offset:6144
    ds_read_b128 v[24:27], v30 offset:6656
    s_mov_b64 exec, -1
    v_exp_f32 v34, v34
    v_exp_f32 v35, v35
    v_exp_f32 v36, v36
    s_waitcnt lgkmcnt(2)
    v_mfma_f32_32x32x16_bf16 v[48:63], v[8:11], v[4:7], 0
    ds_read_b128 v[8:11], v29 offset:8192
    v_exp_f32 v37, v37
    v_exp_f32 v38, v38
    v_exp_f32 v39, v39
    v_exp_f32 v40, v40
    v_exp_f32 v41, v41
    v_smfmac_f32_32x32x32_bf16 v[64:79], v[12:15], v[32:39], v28
    v_exp_f32 v42, v42
    v_exp_f32 v43, v43
    v_exp_f32 v44, v44
    v_exp_f32 v45, v45
    v_exp_f32 v46, v46
    v_exp_f32 v47, v47
    s_setprio 0
    v_exp_f32 v48, v48
    v_exp_f32 v49, v49
    v_smfmac_f32_32x32x32_bf16 v[64:79], v[16:19], v[40:47], v28
    s_mov_b64 exec, s[66:67]
    ds_read_b128 v[12:15], v30 offset:8192
    ds_read_b128 v[16:19], v30 offset:8704
    s_mov_b64 exec, -1
    v_exp_f32 v50, v50
    v_exp_f32 v51, v51
    v_exp_f32 v52, v52
    s_waitcnt lgkmcnt(2)
    v_mfma_f32_32x32x16_bf16 v[32:47], v[8:11], v[4:7], 0
    ds_read_b128 v[8:11], v29 offset:10240
    v_exp_f32 v53, v53
    v_exp_f32 v54, v54
    v_exp_f32 v55, v55
    v_exp_f32 v56, v56
    v_exp_f32 v57, v57
    v_smfmac_f32_32x32x32_bf16 v[64:79], v[20:23], v[48:55], v28
    v_exp_f32 v58, v58
    v_exp_f32 v59, v59
    v_exp_f32 v60, v60
    v_exp_f32 v61, v61
    v_exp_f32 v62, v62
    v_exp_f32 v63, v63
    s_setprio 3
    v_exp_f32 v32, v32
    v_exp_f32 v33, v33
    v_smfmac_f32_32x32x32_bf16 v[64:79], v[24:27], v[56:63], v28
    s_mov_b64 exec, s[66:67]
    ds_read_b128 v[20:23], v30 offset:10240
    ds_read_b128 v[24:27], v30 offset:10752
    s_mov_b64 exec, -1
    v_exp_f32 v34, v34
    v_exp_f32 v35, v35
    v_exp_f32 v36, v36
    s_waitcnt lgkmcnt(2)
    v_mfma_f32_32x32x16_bf16 v[48:63], v[8:11], v[4:7], 0
    ds_read_b128 v[8:11], v29 offset:12288
    ds_read_b32 v97, v1 offset:184
    v_exp_f32 v37, v37
    v_exp_f32 v38, v38
    v_exp_f32 v39, v39
    v_exp_f32 v40, v40
    v_exp_f32 v41, v41
    v_smfmac_f32_32x32x32_bf16 v[64:79], v[12:15], v[32:39], v28
    v_exp_f32 v42, v42
    v_exp_f32 v43, v43
    v_exp_f32 v44, v44
    v_exp_f32 v45, v45
    v_exp_f32 v46, v46
    v_exp_f32 v47, v47
    s_setprio 2
    v_exp_f32 v48, v48
    v_exp_f32 v49, v49
    v_smfmac_f32_32x32x32_bf16 v[64:79], v[16:19], v[40:47], v28
    s_mov_b64 exec, s[66:67]
    ds_read_b128 v[12:15], v30 offset:12288
    ds_read_b128 v[16:19], v30 offset:12800
    s_mov_b64 exec, -1
    v_exp_f32 v50, v50
    v_exp_f32 v51, v51
    v_exp_f32 v52, v52
    s_waitcnt lgkmcnt(2)
    v_mfma_f32_32x32x16_bf16 v[32:47], v[8:11], v[4:7], 0
    ds_read_b128 v[8:11], v29 offset:14336
    v_exp_f32 v53, v53
    v_exp_f32 v54, v54
    v_exp_f32 v55, v55
    v_exp_f32 v56, v56
    v_exp_f32 v57, v57
    v_smfmac_f32_32x32x32_bf16 v[64:79], v[20:23], v[48:55], v28
    v_cmp_gt_u32 vcc, 1, v97
    s_cbranch_vccnz CK1
CK1R:
    v_exp_f32 v58, v58
    v_exp_f32 v59, v59
    v_exp_f32 v60, v60
    v_exp_f32 v61, v61
    v_exp_f32 v62, v62
    v_exp_f32 v63, v63
    s_setprio 1
    v_exp_f32 v32, v32
    v_exp_f32 v33, v33
    v_smfmac_f32_32x32x32_bf16 v[64:79], v[24:27], v[56:63], v28
    s_mov_b64 exec, s[66:67]
    ds_read_b128 v[20:23], v30 offset:14336
    ds_read_b128 v[24:27], v30 offset:14848
    s_mov_b64 exec, -1
    v_exp_f32 v34, v34
    v_exp_f32 v35, v35
    v_exp_f32 v36, v36
    s_waitcnt lgkmcnt(2)
    v_mfma_f32_32x32x16_bf16 v[48:63], v[8:11], v[4:7], 0
    ds_read_b128 v[8:11], v29 offset:16384
    v_exp_f32 v37, v37
    v_exp_f32 v38, v38
    v_exp_f32 v39, v39
    v_exp_f32 v40, v40
    v_exp_f32 v41, v41
    v_smfmac_f32_32x32x32_bf16 v[64:79], v[12:15], v[32:39], v28
    v_exp_f32 v42, v42
    v_exp_f32 v43, v43
    v_exp_f32 v44, v44
    v_exp_f32 v45, v45
    v_exp_f32 v46, v46
    v_exp_f32 v47, v47
    s_setprio 0
    v_exp_f32 v48, v48
    v_exp_f32 v49, v49
    v_smfmac_f32_32x32x32_bf16 v[64:79], v[16:19], v[40:47], v28
    s_mov_b64 exec, s[66:67]
    ds_read_b128 v[12:15], v30 offset:16384
    ds_read_b128 v[16:19], v30 offset:16896
    s_mov_b64 exec, -1
    v_exp_f32 v50, v50
    v_exp_f32 v51, v51
    v_exp_f32 v52, v52
    s_waitcnt lgkmcnt(2)
    v_mfma_f32_32x32x16_bf16 v[32:47], v[8:11], v[4:7], 0
    ds_read_b128 v[8:11], v29 offset:18432
    v_exp_f32 v53, v53
    v_exp_f32 v54, v54
    v_exp_f32 v55, v55
    v_exp_f32 v56, v56
    v_exp_f32 v57, v57
    v_smfmac_f32_32x32x32_bf16 v[64:79], v[20:23], v[48:55], v28
    v_exp_f32 v58, v58
    v_exp_f32 v59, v59
    v_exp_f32 v60, v60
    v_exp_f32 v61, v61
    v_exp_f32 v62, v62
    v_exp_f32 v63, v63
    s_setprio 3
    v_exp_f32 v32, v32
    v_exp_f32 v33, v33
    v_smfmac_f32_32x32x32_bf16 v[64:79], v[24:27], v[56:63], v28
    s_mov_b64 exec, s[66:67]
    ds_read_b128 v[20:23], v30 offset:18432
    ds_read_b128 v[24:27], v30 offset:18944
    s_mov_b64 exec, -1
    v_exp_f32 v34, v34
    v_exp_f32 v35, v35
    v_exp_f32 v36, v36
    s_waitcnt lgkmcnt(2)
    v_mfma_f32_32x32x16_bf16 v[48:63], v[8:11], v[4:7], 0
    ds_read_b128 v[8:11], v29 offset:20480
    v_exp_f32 v37, v37
    v_exp_f32 v38, v38
    v_exp_f32 v39, v39
    v_exp_f32 v40, v40
    v_exp_f32 v41, v41
    v_smfmac_f32_32x32x32_bf16 v[64:79], v[12:15], v[32:39], v28
    v_exp_f32 v42, v42
    v_exp_f32 v43, v43
    v_exp_f32 v44, v44
    v_exp_f32 v45, v45
    v_exp_f32 v46, v46
    v_exp_f32 v47, v47
    s_setprio 2
    v_exp_f32 v48, v48
    v_exp_f32 v49, v49
    v_smfmac_f32_32x32x32_bf16 v[64:79], v[16:19], v[40:47], v28
    s_mov_b64 exec, s[66:67]
    ds_read_b128 v[12:15], v30 offset:20480
    ds_read_b128 v[16:19], v30 offset:20992
    s_mov_b64 exec, -1
    v_exp_f32 v50, v50
    v_exp_f32 v51, v51
    v_exp_f32 v52, v52
    s_waitcnt lgkmcnt(2)
    v_mfma_f32_32x32x16_bf16 v[32:47], v[8:11], v[4:7], 0
    ds_read_b128 v[8:11], v29 offset:22528
    v_exp_f32 v53, v53
    v_exp_f32 v54, v54
    v_exp_f32 v55, v55
    v_exp_f32 v56, v56
    v_exp_f32 v57, v57
    v_smfmac_f32_32x32x32_bf16 v[64:79], v[20:23], v[48:55], v28
    v_exp_f32 v58, v58
    v_exp_f32 v59, v59
    v_exp_f32 v60, v60
    v_exp_f32 v61, v61
    v_exp_f32 v62, v62
    v_exp_f32 v63, v63
    s_setprio 1
    v_exp_f32 v32, v32
    v_exp_f32 v33, v33
    v_smfmac_f32_32x32x32_bf16 v[64:79], v[24:27], v[56:63], v28
    s_mov_b64 exec, s[66:67]
    ds_read_b128 v[20:23], v30 offset:22528
    ds_read_b128 v[24:27], v30 offset:23040
    s_mov_b64 exec, -1
    v_exp_f32 v34, v34
    v_exp_f32 v35, v35
    v_exp_f32 v36, v36
    s_waitcnt lgkmcnt(2)
    v_mfma_f32_32x32x16_bf16 v[48:63], v[8:11], v[4:7], 0
    ds_read_b128 v[8:11], v29 offset:24576
    v_exp_f32 v37, v37
    v_exp_f32 v38, v38
    v_exp_f32 v39, v39
    v_exp_f32 v40, v40
    v_exp_f32 v41, v41
    v_smfmac_f32_32x32x32_bf16 v[64:79], v[12:15], v[32:39], v28
    v_exp_f32 v42, v42
    v_exp_f32 v43, v43
    v_exp_f32 v44, v44
    v_exp_f32 v45, v45
    v_exp_f32 v46, v46
    v_exp_f32 v47, v47
    s_setprio 0
    v_exp_f32 v48, v48
    v_exp_f32 v49, v49
    v_smfmac_f32_32x32x32_bf16 v[64:79], v[16:19], v[40:47], v28
    s_mov_b64 exec, s[66:67]
    ds_read_b128 v[12:15], v30 offset:24576
    ds_read_b128 v[16:19], v30 offset:25088
    s_mov_b64 exec, -1
    v_exp_f32 v50, v50
    v_exp_f32 v51, v51
    v_exp_f32 v52, v52
    s_waitcnt lgkmcnt(2)
    v_mfma_f32_32x32x16_bf16 v[32:47], v[8:11], v[4:7], 0
    ds_read_b128 v[8:11], v29 offset:26624
    v_exp_f32 v53, v53
    v_exp_f32 v54, v54
    v_exp_f32 v55, v55
    v_exp_f32 v56, v56
    v_exp_f32 v57, v57
    v_smfmac_f32_32x32x32_bf16 v[64:79], v[20:23], v[48:55], v28
    v_exp_f32 v58, v58
    v_exp_f32 v59, v59
    v_exp_f32 v60, v60
    v_exp_f32 v61, v61
    v_exp_f32 v62, v62
    v_exp_f32 v63, v63
    s_setprio 3
    v_exp_f32 v32, v32
    v_exp_f32 v33, v33
    v_smfmac_f32_32x32x32_bf16 v[64:79], v[24:27], v[56:63], v28
    s_mov_b64 exec, s[66:67]
    ds_read_b128 v[20:23], v30 offset:26624
    ds_read_b128 v[24:27], v30 offset:27136
    s_mov_b64 exec, -1
    v_exp_f32 v34, v34
    v_exp_f32 v35, v35
    v_exp_f32 v36, v36
    s_waitcnt lgkmcnt(2)
    v_mfma_f32_32x32x16_bf16 v[48:63], v[8:11], v[4:7], 0
    ds_read_b128 v[8:11], v29 offset:28672
    s_waitcnt vmcnt(0)
    s_mov_b64 exec, 1
    ds_add_u32 v1, v0 offset:196
    s_mov_b64 exec, -1
    v_exp_f32 v37, v37
    v_exp_f32 v38, v38
    v_exp_f32 v39, v39
    v_exp_f32 v40, v40
    v_exp_f32 v41, v41
    v_smfmac_f32_32x32x32_bf16 v[64:79], v[12:15], v[32:39], v28
    v_exp_f32 v42, v42
    v_exp_f32 v43, v43
    v_exp_f32 v44, v44
    v_exp_f32 v45, v45
    v_exp_f32 v46, v46
    v_exp_f32 v47, v47
    s_setprio 2
    v_exp_f32 v48, v48
    v_exp_f32 v49, v49
    v_smfmac_f32_32x32x32_bf16 v[64:79], v[16:19], v[40:47], v28
    s_mov_b64 exec, s[66:67]
    ds_read_b128 v[12:15], v30 offset:28672
    ds_read_b128 v[16:19], v30 offset:29184
    s_mov_b64 exec, -1
    v_exp_f32 v50, v50
    v_exp_f32 v51, v51
    v_exp_f32 v52, v52
    s_waitcnt lgkmcnt(2)
    v_mfma_f32_32x32x16_bf16 v[32:47], v[8:11], v[4:7], 0
    ds_read_b128 v[8:11], v29 offset:30720
    buffer_load_dwordx4 v[100:103], v154, s[32:35], s44 offen
    v_exp_f32 v53, v53
    v_exp_f32 v54, v54
    v_exp_f32 v55, v55
    v_exp_f32 v56, v56
    v_exp_f32 v57, v57
    v_smfmac_f32_32x32x32_bf16 v[64:79], v[20:23], v[48:55], v28
    v_exp_f32 v58, v58
    v_exp_f32 v59, v59
    v_exp_f32 v60, v60
    v_exp_f32 v61, v61
    v_exp_f32 v62, v62
    v_exp_f32 v63, v63
    s_setprio 1
    v_exp_f32 v32, v32
    v_exp_f32 v33, v33
    v_smfmac_f32_32x32x32_bf16 v[64:79], v[24:27], v[56:63], v28
    s_mov_b64 exec, s[66:67]
    ds_read_b128 v[20:23], v30 offset:30720
    ds_read_b128 v[24:27], v30 offset:31232
    s_mov_b64 exec, -1
    v_exp_f32 v34, v34
    v_exp_f32 v35, v35
    v_exp_f32 v36, v36
    s_waitcnt lgkmcnt(2)
    v_mfma_f32_32x32x16_bf16 v[48:63], v[8:11], v[4:7], 0
    ds_read_b128 v[8:11], v29 offset:32768
    ds_read_b32 v97, v1 offset:188
    v_exp_f32 v37, v37
    v_exp_f32 v38, v38
    v_exp_f32 v39, v39
    v_exp_f32 v40, v40
    v_exp_f32 v41, v41
    v_smfmac_f32_32x32x32_bf16 v[64:79], v[12:15], v[32:39], v28
    v_exp_f32 v42, v42
    v_exp_f32 v43, v43
    v_exp_f32 v44, v44
    v_exp_f32 v45, v45
    v_exp_f32 v46, v46
    v_exp_f32 v47, v47
    s_setprio 0
    v_exp_f32 v48, v48
    v_exp_f32 v49, v49
    v_smfmac_f32_32x32x32_bf16 v[64:79], v[16:19], v[40:47], v28
    s_mov_b64 exec, s[66:67]
    ds_read_b128 v[12:15], v30 offset:32768
    ds_read_b128 v[16:19], v30 offset:33280
    s_mov_b64 exec, -1
    v_exp_f32 v50, v50
    v_exp_f32 v51, v51
    v_exp_f32 v52, v52
    s_waitcnt lgkmcnt(2)
    v_mfma_f32_32x32x16_bf16 v[32:47], v[8:11], v[4:7], 0
    ds_read_b128 v[8:11], v29 offset:34816
    v_exp_f32 v53, v53
    v_exp_f32 v54, v54
    v_exp_f32 v55, v55
    v_exp_f32 v56, v56
    v_exp_f32 v57, v57
    v_smfmac_f32_32x32x32_bf16 v[64:79], v[20:23], v[48:55], v28
    v_cmp_gt_u32 vcc, 2, v97
    s_cbranch_vccnz CK2
CK2R:
    v_exp_f32 v58, v58
    v_exp_f32 v59, v59
    v_exp_f32 v60, v60
    v_exp_f32 v61, v61
    v_exp_f32 v62, v62
    v_exp_f32 v63, v63
    s_setprio 3
    v_exp_f32 v32, v32
    v_exp_f32 v33, v33
    v_smfmac_f32_32x32x32_bf16 v[64:79], v[24:27], v[56:63], v28
    s_mov_b64 exec, s[66:67]
    ds_read_b128 v[20:23], v30 offset:34816
    ds_read_b128 v[24:27], v30 offset:35328
    s_mov_b64 exec, -1
    v_exp_f32 v34, v34
    v_exp_f32 v35, v35
    v_exp_f32 v36, v36
    s_waitcnt lgkmcnt(2)
    v_mfma_f32_32x32x16_bf16 v[48:63], v[8:11], v[4:7], 0
    ds_read_b128 v[8:11], v29 offset:36864
    buffer_load_dwordx4 v[104:107], v3, s[28:31], s55 offen offset:0 sc1
    v_exp_f32 v37, v37
    v_exp_f32 v38, v38
    v_exp_f32 v39, v39
    v_exp_f32 v40, v40
    v_exp_f32 v41, v41
    v_smfmac_f32_32x32x32_bf16 v[64:79], v[12:15], v[32:39], v28
    buffer_load_dwordx4 v[108:111], v3, s[28:31], s55 offen offset:1024 sc1
    v_exp_f32 v42, v42
    v_exp_f32 v43, v43
    v_exp_f32 v44, v44
    v_exp_f32 v45, v45
    v_exp_f32 v46, v46
    v_exp_f32 v47, v47
    s_setprio 2
    v_exp_f32 v48, v48
    v_exp_f32 v49, v49
    v_smfmac_f32_32x32x32_bf16 v[64:79], v[16:19], v[40:47], v28
    s_mov_b64 exec, s[66:67]
    ds_read_b128 v[12:15], v30 offset:36864
    ds_read_b128 v[16:19], v30 offset:37376
    s_mov_b64 exec, -1
    v_exp_f32 v50, v50
    v_exp_f32 v51, v51
    v_exp_f32 v52, v52
    s_waitcnt lgkmcnt(2)
    v_mfma_f32_32x32x16_bf16 v[32:47], v[8:11], v[4:7], 0
    ds_read_b128 v[8:11], v29 offset:38912
    buffer_load_dwordx4 v[112:115], v3, s[28:31], s55 offen offset:2048 sc1
    v_exp_f32 v53, v53
    v_exp_f32 v54, v54
    v_exp_f32 v55, v55
    v_exp_f32 v56, v56
    v_exp_f32 v57, v57
    v_smfmac_f32_32x32x32_bf16 v[64:79], v[20:23], v[48:55], v28
    buffer_load_dwordx4 v[116:119], v3, s[28:31], s55 offen offset:3072 sc1
    s_add_u32 s55, s55, 4096
    v_exp_f32 v58, v58
    v_exp_f32 v59, v59
    v_exp_f32 v60, v60
    v_exp_f32 v61, v61
    v_exp_f32 v62, v62
    v_exp_f32 v63, v63
    s_setprio 1
    v_exp_f32 v32, v32
    v_exp_f32 v33, v33
    v_smfmac_f32_32x32x32_bf16 v[64:79], v[24:27], v[56:63], v28
    s_mov_b64 exec, s[66:67]
    ds_read_b128 v[20:23], v30 offset:38912
    ds_read_b128 v[24:27], v30 offset:39424
    s_mov_b64 exec, -1
    v_exp_f32 v34, v34
    v_exp_f32 v35, v35
    v_exp_f32 v36, v36
    s_waitcnt lgkmcnt(2)
    v_mfma_f32_32x32x16_bf16 v[48:63], v[8:11], v[4:7], 0
    ds_read_b128 v[8:11], v29 offset:40960
    buffer_load_dwordx4 v[120:123], v3, s[28:31], s55 offen offset:0 sc1
    v_exp_f32 v37, v37
    v_exp_f32 v38, v38
    v_exp_f32 v39, v39
    v_exp_f32 v40, v40
    v_exp_f32 v41, v41
    v_smfmac_f32_32x32x32_bf16 v[64:79], v[12:15], v[32:39], v28
    buffer_load_dwordx4 v[124:127], v3, s[28:31], s55 offen offset:1024 sc1
    v_exp_f32 v42, v42
    v_exp_f32 v43, v43
    v_exp_f32 v44, v44
    v_exp_f32 v45, v45
    v_exp_f32 v46, v46
    v_exp_f32 v47, v47
    s_setprio 0
    v_exp_f32 v48, v48
    v_exp_f32 v49, v49
    v_smfmac_f32_32x32x32_bf16 v[64:79], v[16:19], v[40:47], v28
    s_mov_b64 exec, s[66:67]
    ds_read_b128 v[12:15], v30 offset:40960
    ds_read_b128 v[16:19], v30 offset:41472
    s_mov_b64 exec, -1
    v_exp_f32 v50, v50
    v_exp_f32 v51, v51
    v_exp_f32 v52, v52
    s_waitcnt lgkmcnt(2)
    v_mfma_f32_32x32x16_bf16 v[32:47], v[8:11], v[4:7], 0
    ds_read_b128 v[8:11], v29 offset:43008
    buffer_load_dwordx4 v[128:131], v3, s[28:31], s55 offen offset:2048 sc1
    v_exp_f32 v53, v53
    v_exp_f32 v54, v54
    v_exp_f32 v55, v55
    v_exp_f32 v56, v56
    v_exp_f32 v57, v57
    v_smfmac_f32_32x32x32_bf16 v[64:79], v[20:23], v[48:55], v28
    buffer_load_dwordx4 v[132:135], v3, s[28:31], s55 offen offset:3072 sc1
    s_add_u32 s55, s55, 4096
    v_exp_f32 v58, v58
    v_exp_f32 v59, v59
    v_exp_f32 v60, v60
    v_exp_f32 v61, v61
    v_exp_f32 v62, v62
    v_exp_f32 v63, v63
    s_setprio 3
    v_exp_f32 v32, v32
    v_exp_f32 v33, v33
    v_smfmac_f32_32x32x32_bf16 v[64:79], v[24:27], v[56:63], v28
    s_mov_b64 exec, s[66:67]
    ds_read_b128 v[20:23], v30 offset:43008
    ds_read_b128 v[24:27], v30 offset:43520
    s_mov_b64 exec, -1
    v_exp_f32 v34, v34
    v_exp_f32 v35, v35
    v_exp_f32 v36, v36
    s_waitcnt lgkmcnt(2)
    v_mfma_f32_32x32x16_bf16 v[48:63], v[8:11], v[4:7], 0
    ds_read_b128 v[8:11], v29 offset:45056
    buffer_load_dwordx4 v[136:139], v3, s[28:31], s55 offen offset:0 sc1
    v_exp_f32 v37, v37
    v_exp_f32 v38, v38
    v_exp_f32 v39, v39
    v_exp_f32 v40, v40
    v_exp_f32 v41, v41
    v_smfmac_f32_32x32x32_bf16 v[64:79], v[12:15], v[32:39], v28
    buffer_load_dwordx4 v[140:143], v3, s[28:31], s55 offen offset:1024 sc1
    v_exp_f32 v42, v42
    v_exp_f32 v43, v43
    v_exp_f32 v44, v44
    v_exp_f32 v45, v45
    v_exp_f32 v46, v46
    v_exp_f32 v47, v47
    s_setprio 2
    v_exp_f32 v48, v48
    v_exp_f32 v49, v49
    v_smfmac_f32_32x32x32_bf16 v[64:79], v[16:19], v[40:47], v28
    s_mov_b64 exec, s[66:67]
    ds_read_b128 v[12:15], v30 offset:45056
    ds_read_b128 v[16:19], v30 offset:45568
    s_mov_b64 exec, -1
    v_exp_f32 v50, v50
    v_exp_f32 v51, v51
    v_exp_f32 v52, v52
    s_waitcnt lgkmcnt(2)
    v_mfma_f32_32x32x16_bf16 v[32:47], v[8:11], v[4:7], 0
    ds_read_b128 v[8:11], v29 offset:47104
    buffer_load_dwordx4 v[144:147], v3, s[28:31], s55 offen offset:2048 sc1
    v_exp_f32 v53, v53
    v_exp_f32 v54, v54
    v_exp_f32 v55, v55
    v_exp_f32 v56, v56
    v_exp_f32 v57, v57
    v_smfmac_f32_32x32x32_bf16 v[64:79], v[20:23], v[48:55], v28
    buffer_load_dwordx4 v[148:151], v3, s[28:31], s55 offen offset:3072 sc1
    s_add_u32 s55, s55, 4096
    v_exp_f32 v58, v58
    v_exp_f32 v59, v59
    v_exp_f32 v60, v60
    v_exp_f32 v61, v61
    v_exp_f32 v62, v62
    v_exp_f32 v63, v63
    s_setprio 1
    v_exp_f32 v32, v32
    v_exp_f32 v33, v33
    v_smfmac_f32_32x32x32_bf16 v[64:79], v[24:27], v[56:63], v28
    s_mov_b64 exec, s[66:67]
    ds_read_b128 v[20:23], v30 offset:47104
    ds_read_b128 v[24:27], v30 offset:47616
    s_mov_b64 exec, -1
    v_exp_f32 v34, v34
    v_exp_f32 v35, v35
    v_exp_f32 v36, v36
    s_waitcnt lgkmcnt(2)
    v_mfma_f32_32x32x16_bf16 v[48:63], v[8:11], v[4:7], 0
    ds_read_b128 v[8:11], v29 offset:49152
    buffer_load_dwordx4 v[152:155], v3, s[28:31], s55 offen offset:0 sc1
    v_exp_f32 v37, v37
    v_exp_f32 v38, v38
    v_exp_f32 v39, v39
    v_exp_f32 v40, v40
    v_exp_f32 v41, v41
    v_smfmac_f32_32x32x32_bf16 v[64:79], v[12:15], v[32:39], v28
    buffer_load_dwordx4 v[156:159], v3, s[28:31], s55 offen offset:1024 sc1
    v_exp_f32 v42, v42
    v_exp_f32 v43, v43
    v_exp_f32 v44, v44
    v_exp_f32 v45, v45
    v_exp_f32 v46, v46
    v_exp_f32 v47, v47
    s_setprio 0
    v_exp_f32 v48, v48
    v_exp_f32 v49, v49
    v_smfmac_f32_32x32x32_bf16 v[64:79], v[16:19], v[40:47], v28
    s_mov_b64 exec, s[66:67]
    ds_read_b128 v[12:15], v30 offset:49152
    ds_read_b128 v[16:19], v30 offset:49664
    s_mov_b64 exec, -1
    v_exp_f32 v50, v50
    v_exp_f32 v51, v51
    v_exp_f32 v52, v52
    s_waitcnt lgkmcnt(2)
    v_mfma_f32_32x32x16_bf16 v[32:47], v[8:11], v[4:7], 0
    ds_read_b128 v[8:11], v29 offset:51200
    buffer_load_dwordx4 v[160:163], v3, s[28:31], s55 offen offset:2048 sc1
    v_exp_f32 v53, v53
    v_exp_f32 v54, v54
    v_exp_f32 v55, v55
    v_exp_f32 v56, v56
    v_exp_f32 v57, v57
    v_smfmac_f32_32x32x32_bf16 v[64:79], v[20:23], v[48:55], v28
    buffer_load_dwordx4 v[164:167], v3, s[28:31], s55 offen offset:3072 sc1
    s_add_u32 s55, s55, 4096
    v_exp_f32 v58, v58
    v_exp_f32 v59, v59
    v_exp_f32 v60, v60
    v_exp_f32 v61, v61
    v_exp_f32 v62, v62
    v_exp_f32 v63, v63
    v_add_u32 v29, 49152, v29
    v_add_u32 v30, 49152, v30
.p2align 6
LOOP:
    s_setprio 3
    v_exp_f32 v32, v32
    v_exp_f32 v33, v33
    v_smfmac_f32_32x32x32_bf16 v[64:79], v[24:27], v[56:63], v28
    s_mov_b64 exec, s[66:67]
    ds_read_b128 v[20:23], v30 offset:2048
    ds_read_b128 v[24:27], v30 offset:2560
    s_mov_b64 exec, -1
    v_exp_f32 v34, v34
    v_exp_f32 v35, v35
    v_exp_f32 v36, v36
    s_waitcnt lgkmcnt(2)
    v_mfma_f32_32x32x16_bf16 v[48:63], v[8:11], v[4:7], 0
    ds_read_b128 v[8:11], v29 offset:4096
    v_exp_f32 v37, v37
    v_exp_f32 v38, v38
    v_exp_f32 v39, v39
    v_exp_f32 v40, v40
    v_exp_f32 v41, v41
    v_smfmac_f32_32x32x32_bf16 v[64:79], v[12:15], v[32:39], v28
    v_exp_f32 v42, v42
    v_exp_f32 v43, v43
    v_exp_f32 v44, v44
    v_exp_f32 v45, v45
    v_exp_f32 v46, v46
    v_exp_f32 v47, v47
    s_setprio 2
    v_exp_f32 v48, v48
    v_exp_f32 v49, v49
    v_smfmac_f32_32x32x32_bf16 v[64:79], v[16:19], v[40:47], v28
    s_mov_b64 exec, s[66:67]
    ds_read_b128 v[12:15], v30 offset:4096
    ds_read_b128 v[16:19], v30 offset:4608
    s_mov_b64 exec, -1
    v_exp_f32 v50, v50
    v_exp_f32 v51, v51
    v_exp_f32 v52, v52
    s_waitcnt lgkmcnt(2)
    v_mfma_f32_32x32x16_bf16 v[32:47], v[8:11], v[4:7], 0
    ds_read_b128 v[8:11], v29 offset:6144
    v_exp_f32 v53, v53
    v_exp_f32 v54, v54
    v_exp_f32 v55, v55
    v_exp_f32 v56, v56
    v_exp_f32 v57, v57
    v_smfmac_f32_32x32x32_bf16 v[64:79], v[20:23], v[48:55], v28
    v_exp_f32 v58, v58
    v_exp_f32 v59, v59
    v_exp_f32 v60, v60
    v_exp_f32 v61, v61
    v_exp_f32 v62, v62
    v_exp_f32 v63, v63
    s_setprio 1
    v_exp_f32 v32, v32
    v_exp_f32 v33, v33
    v_smfmac_f32_32x32x32_bf16 v[64:79], v[24:27], v[56:63], v28
    s_mov_b64 exec, s[66:67]
    ds_read_b128 v[20:23], v30 offset:6144
    ds_read_b128 v[24:27], v30 offset:6656
    s_mov_b64 exec, -1
    v_exp_f32 v34, v34
    v_exp_f32 v35, v35
    v_exp_f32 v36, v36
    s_waitcnt lgkmcnt(2)
    v_mfma_f32_32x32x16_bf16 v[48:63], v[8:11], v[4:7], 0
    ds_read_b128 v[8:11], v29 offset:8192
    v_exp_f32 v37, v37
    v_exp_f32 v38, v38
    v_exp_f32 v39, v39
    v_exp_f32 v40, v40
    v_exp_f32 v41, v41
    v_smfmac_f32_32x32x32_bf16 v[64:79], v[12:15], v[32:39], v28
    v_exp_f32 v42, v42
    v_exp_f32 v43, v43
    v_exp_f32 v44, v44
    v_exp_f32 v45, v45
    v_exp_f32 v46, v46
    v_exp_f32 v47, v47
    s_setprio 0
    v_exp_f32 v48, v48
    v_exp_f32 v49, v49
    v_smfmac_f32_32x32x32_bf16 v[64:79], v[16:19], v[40:47], v28
    s_mov_b64 exec, s[66:67]
    ds_read_b128 v[12:15], v30 offset:8192
    ds_read_b128 v[16:19], v30 offset:8704
    s_mov_b64 exec, -1
    v_exp_f32 v50, v50
    v_exp_f32 v51, v51
    v_exp_f32 v52, v52
    s_waitcnt lgkmcnt(2)
    v_mfma_f32_32x32x16_bf16 v[32:47], v[8:11], v[4:7], 0
    ds_read_b128 v[8:11], v29 offset:10240
    v_exp_f32 v53, v53
    v_exp_f32 v54, v54
    v_exp_f32 v55, v55
    v_exp_f32 v56, v56
    v_exp_f32 v57, v57
    v_smfmac_f32_32x32x32_bf16 v[64:79], v[20:23], v[48:55], v28
    v_exp_f32 v58, v58
    v_exp_f32 v59, v59
    v_exp_f32 v60, v60
    v_exp_f32 v61, v61
    v_exp_f32 v62, v62
    v_exp_f32 v63, v63
    s_setprio 3
    v_exp_f32 v32, v32
    v_exp_f32 v33, v33
    v_smfmac_f32_32x32x32_bf16 v[64:79], v[24:27], v[56:63], v28
    s_mov_b64 exec, s[66:67]
    ds_read_b128 v[20:23], v30 offset:10240
    ds_read_b128 v[24:27], v30 offset:10752
    s_mov_b64 exec, -1
    v_exp_f32 v34, v34
    v_exp_f32 v35, v35
    v_exp_f32 v36, v36
    s_waitcnt lgkmcnt(2)
    v_mfma_f32_32x32x16_bf16 v[48:63], v[8:11], v[4:7], 0
    ds_read_b128 v[8:11], v29 offset:12288
    v_exp_f32 v37, v37
    v_exp_f32 v38, v38
    v_exp_f32 v39, v39
    v_exp_f32 v40, v40
    v_exp_f32 v41, v41
    v_smfmac_f32_32x32x32_bf16 v[64:79], v[12:15], v[32:39], v28
    v_exp_f32 v42, v42
    v_exp_f32 v43, v43
    v_exp_f32 v44, v44
    v_exp_f32 v45, v45
    v_exp_f32 v46, v46
    v_exp_f32 v47, v47
    s_setprio 2
    v_exp_f32 v48, v48
    v_exp_f32 v49, v49
    v_smfmac_f32_32x32x32_bf16 v[64:79], v[16:19], v[40:47], v28
    s_mov_b64 exec, s[66:67]
    ds_read_b128 v[12:15], v30 offset:12288
    ds_read_b128 v[16:19], v30 offset:12800
    s_mov_b64 exec, -1
    v_exp_f32 v50, v50
    v_exp_f32 v51, v51
    v_exp_f32 v52, v52
    s_waitcnt lgkmcnt(2)
    v_mfma_f32_32x32x16_bf16 v[32:47], v[8:11], v[4:7], 0
    ds_read_b128 v[8:11], v29 offset:14336
    v_exp_f32 v53, v53
    v_exp_f32 v54, v54
    v_exp_f32 v55, v55
    v_exp_f32 v56, v56
    v_exp_f32 v57, v57
    v_smfmac_f32_32x32x32_bf16 v[64:79], v[20:23], v[48:55], v28
    v_exp_f32 v58, v58
    v_exp_f32 v59, v59
    v_exp_f32 v60, v60
    v_exp_f32 v61, v61
    v_exp_f32 v62, v62
    v_exp_f32 v63, v63
    s_setprio 1
    v_exp_f32 v32, v32
    v_exp_f32 v33, v33
    v_smfmac_f32_32x32x32_bf16 v[64:79], v[24:27], v[56:63], v28
    s_mov_b64 exec, s[66:67]
    ds_read_b128 v[20:23], v30 offset:14336
    ds_read_b128 v[24:27], v30 offset:14848
    s_mov_b64 exec, -1
    v_exp_f32 v34, v34
    v_exp_f32 v35, v35
    v_exp_f32 v36, v36
    s_waitcnt lgkmcnt(2)
    v_mfma_f32_32x32x16_bf16 v[48:63], v[8:11], v[4:7], 0
    ds_read_b128 v[8:11], v29 offset:16384
    v_exp_f32 v37, v37
    v_exp_f32 v38, v38
    v_exp_f32 v39, v39
    v_exp_f32 v40, v40
    v_exp_f32 v41, v41
    v_smfmac_f32_32x32x32_bf16 v[64:79], v[12:15], v[32:39], v28
    v_exp_f32 v42, v42
    v_exp_f32 v43, v43
    v_exp_f32 v44, v44
    v_exp_f32 v45, v45
    v_exp_f32 v46, v46
    v_exp_f32 v47, v47
    s_setprio 0
    v_exp_f32 v48, v48
    v_exp_f32 v49, v49
    v_smfmac_f32_32x32x32_bf16 v[64:79], v[16:19], v[40:47], v28
    s_mov_b64 exec, s[66:67]
    ds_read_b128 v[12:15], v30 offset:16384
    ds_read_b128 v[16:19], v30 offset:16896
    s_mov_b64 exec, -1
    v_exp_f32 v50, v50
    v_exp_f32 v51, v51
    v_exp_f32 v52, v52
    s_waitcnt lgkmcnt(2)
    v_mfma_f32_32x32x16_bf16 v[32:47], v[8:11], v[4:7], 0
    ds_read_b128 v[8:11], v29 offset:18432
    v_exp_f32 v53, v53
    v_exp_f32 v54, v54
    v_exp_f32 v55, v55
    v_exp_f32 v56, v56
    v_exp_f32 v57, v57
    v_smfmac_f32_32x32x32_bf16 v[64:79], v[20:23], v[48:55], v28
    s_add_u32 s65, s65, 1
    s_cmp_lt_u32 s65, 5
    v_exp_f32 v58, v58
    v_exp_f32 v59, v59
    v_exp_f32 v60, v60
    v_exp_f32 v61, v61
    v_exp_f32 v62, v62
    v_exp_f32 v63, v63
    v_add_u32 v29, 16384, v29
    v_add_u32 v30, 16384, v30
    s_cbranch_scc1 LOOP
LEXIT:
    v_smfmac_f32_32x32x32_bf16 v[64:79], v[24:27], v[56:63], v28
    s_setprio 0
    ds_read_b64 v[98:99], v1 offset:160
    s_lshl_b32 s56, s51, 3
    s_add_u32 s56, s56, s3
    s_lshl_b32 s56, s56, 5
    s_add_u32 s56, s56, s54
    s_lshl_b32 s55, s56, 6
    s_lshl_b32 s56, s56, 10
    s_add_u32 s55, s55, 12632064
    s_add_u32 s64, s56, 6291456
    s_mov_b32 s56, 0x71800000
    s_mov_b32 s57, 0x53800000
    s_mov_b32 s58, 0x2b800000
    s_waitcnt lgkmcnt(0)
    v_rcp_f32 v29, v72
    s_cmp_lg_u32 s68, 0
    s_cbranch_scc1 FIN
    v_add_f32 v31, abs(v64), abs(v65)
    v_add_f32 v31, v31, abs(v66)
    v_add_f32 v31, v31, abs(v67)
    v_add_f32 v31, v31, abs(v68)
    v_add_f32 v31, v31, abs(v69)
    v_add_f32 v31, v31, abs(v70)
    v_add_f32 v31, v31, abs(v71)
    v_cmp_ngt_f32 vcc, s56, v31
    v_cmp_ngt_f32 s[62:63], s57, v72
    v_cmp_nlt_f32 s[70:71], s58, v72
    s_or_b64 s[62:63], s[62:63], s[70:71]
    s_or_b64 s[62:63], vcc, s[62:63]
    s_cbranch_scc1 FALLBACK
FIN:
    v_mul_f32 v64, v64, v29
    v_mul_f32 v65, v65, v29
    v_mul_f32 v66, v66, v29
    v_mul_f32 v67, v67, v29
    v_mul_f32 v68, v68, v29
    v_mul_f32 v69, v69, v29
    v_mul_f32 v70, v70, v29
    v_mul_f32 v71, v71, v29
    v_cvt_pk_bf16_f32 v8, v64, v65
    v_cvt_pk_bf16_f32 v9, v66, v67
    v_cvt_pk_bf16_f32 v10, v68, v69
    v_cvt_pk_bf16_f32 v11, v70, v71
    buffer_store_dwordx4 v[8:11], v3, s[28:31], s64 offen sc1
    s_waitcnt vmcnt(1)
    s_barrier
    v_lshrrev_b32 v4, 3, v2
    v_and_b32 v5, 7, v2
    v_xor_b32 v6, s3, v5
    v_lshlrev_b32 v6, 4, v6
    v_lshl_add_u32 v6, v5, 10, v6
    v_lshl_add_u32 v6, v4, 1, v6
    v_add_u32 v6, 131072, v6
    ds_read_u16_d16_hi v32, v6 offset:0
    ds_read_u16_d16_hi v33, v6 offset:128
    ds_read_u16_d16_hi v34, v6 offset:256
    ds_read_u16_d16_hi v35, v6 offset:384
    ds_read_u16_d16_hi v36, v6 offset:512
    ds_read_u16_d16_hi v37, v6 offset:640
    ds_read_u16_d16_hi v38, v6 offset:768
    ds_read_u16_d16_hi v39, v6 offset:896
    v_lshlrev_b32 v7, 11, v4
    v_lshl_add_u32 v7, v5, 4, v7
    s_lshl_b32 s64, s49, 17
    s_lshl_b32 s57, s3, 14
    s_add_u32 s64, s64, s57
    s_lshl_b32 s57, s48, 7
    s_add_u32 s64, s64, s57
    v_and_b32 v14, 15, v2
    v_lshrrev_b32 v15, 4, v2
    v_lshlrev_b32 v13, 4, v14
    v_lshl_add_u32 v13, v15, 9, v13
    v_and_b32 v12, 1, v15
    v_lshl_add_u32 v14, v12, 4, v14
    v_lshlrev_b32 v14, 11, v14
    v_lshrrev_b32 v15, 1, v15
    v_lshl_add_u32 v14, v15, 4, v14
    s_lshl_b32 s56, s48, 3
    s_add_u32 s56, s56, s51
    s_lshl_b32 s56, s56, 16
    s_lshl_b32 s57, s3, 5
    s_add_u32 s56, s56, s57
    s_lshl_b32 s57, s50, 8
    s_add_u32 s56, s56, s57
    s_add_u32 s56, s56, 1024
    v_mov_b32 v12, 0
    v_lshlrev_b32 v40, 16, v100
    v_and_b32 v41, s59, v100
    v_lshlrev_b32 v42, 16, v101
    v_and_b32 v43, s59, v101
    v_lshlrev_b32 v44, 16, v102
    v_and_b32 v45, s59, v102
    v_lshlrev_b32 v46, 16, v103
    v_and_b32 v47, s59, v103
    s_waitcnt lgkmcnt(0)
    v_and_b32 v32, s59, v32
    v_mul_f32 v32, v32, v40
    v_and_b32 v33, s59, v33
    v_mul_f32 v33, v33, v41
    v_and_b32 v34, s59, v34
    v_mul_f32 v34, v34, v42
    v_and_b32 v35, s59, v35
    v_mul_f32 v35, v35, v43
    v_and_b32 v36, s59, v36
    v_mul_f32 v36, v36, v44
    v_and_b32 v37, s59, v37
    v_mul_f32 v37, v37, v45
    v_and_b32 v38, s59, v38
    v_mul_f32 v38, v38, v46
    v_and_b32 v39, s59, v39
    v_mul_f32 v39, v39, v47
    v_cvt_pk_bf16_f32 v100, v32, v33
    v_cvt_pk_bf16_f32 v101, v34, v35
    v_cvt_pk_bf16_f32 v102, v36, v37
    v_cvt_pk_bf16_f32 v103, v38, v39
    s_waitcnt vmcnt(0)
    s_mov_b64 exec, 1
    buffer_store_dwordx2 v[98:99], v12, s[28:31], s55 offen sc1
    s_mov_b64 exec, -1
    buffer_store_dwordx4 v[100:103], v7, s[36:39], s64 offen
    v_add_u32 v5, 200, v1
    s_mov_b32 s65, 0
GQ:
    ds_read_b32 v4, v5
    s_waitcnt lgkmcnt(0)
GQ2:
    v_readfirstlane_b32 s57, v4
    s_cmp_eq_u32 s57, 0
    s_cbranch_scc1 GQ
    s_lshl_b32 s58, s57, 10
    v_add_u32 v6, s58, v13
    ds_read_b32 v4, v5 offset:4
    ds_read_b128 v[16:19], v6 offset:0
    ds_read_b128 v[20:23], v6 offset:256
    ds_read_b128 v[24:27], v6 offset:2048
    ds_read_b128 v[28:31], v6 offset:2304
    v_add_u32 v5, 4, v5
    s_add_u32 s65, s65, 1
    s_cmp_gt_u32 s57, 16
    s_cbranch_scc1 GH
    s_cmp_eq_u32 s57, 4
    s_cbranch_scc1 GC0
    s_cmp_eq_u32 s57, 8
    s_cbranch_scc1 GC1
    s_cmp_eq_u32 s57, 12
    s_cbranch_scc1 GC2
GC3:
    s_waitcnt lgkmcnt(3)
    v_mfma_f32_16x16x32_bf16 v[56:59], v[128:131], v[16:19], 0
    s_waitcnt lgkmcnt(2)
    v_mfma_f32_16x16x32_bf16 v[60:63], v[128:131], v[20:23], 0
    s_waitcnt lgkmcnt(1)
    v_mfma_f32_16x16x32_bf16 v[56:59], v[132:135], v[24:27], v[56:59]
    s_waitcnt lgkmcnt(0)
    v_mfma_f32_16x16x32_bf16 v[60:63], v[132:135], v[28:31], v[60:63]
    s_cmp_lt_u32 s65, 8
    s_cbranch_scc1 GQ2
    s_branch GE
GH:
    s_cmp_eq_u32 s57, 20
    s_cbranch_scc1 GC4
    s_cmp_eq_u32 s57, 24
    s_cbranch_scc1 GC5
    s_cmp_eq_u32 s57, 28
    s_cbranch_scc1 GC6
GC7:
    s_waitcnt lgkmcnt(3)
    v_mfma_f32_16x16x32_bf16 v[88:91], v[160:163], v[16:19], 0
    s_waitcnt lgkmcnt(2)
    v_mfma_f32_16x16x32_bf16 v[92:95], v[160:163], v[20:23], 0
    s_waitcnt lgkmcnt(1)
    v_mfma_f32_16x16x32_bf16 v[88:91], v[164:167], v[24:27], v[88:91]
    s_waitcnt lgkmcnt(0)
    v_mfma_f32_16x16x32_bf16 v[92:95], v[164:167], v[28:31], v[92:95]
    s_cmp_lt_u32 s65, 8
    s_cbranch_scc1 GQ2
    s_branch GE
GC0:
    s_waitcnt lgkmcnt(3)
    v_mfma_f32_16x16x32_bf16 v[32:35], v[104:107], v[16:19], 0
    s_waitcnt lgkmcnt(2)
    v_mfma_f32_16x16x32_bf16 v[36:39], v[104:107], v[20:23], 0
    s_waitcnt lgkmcnt(1)
    v_mfma_f32_16x16x32_bf16 v[32:35], v[108:111], v[24:27], v[32:35]
    s_waitcnt lgkmcnt(0)
    v_mfma_f32_16x16x32_bf16 v[36:39], v[108:111], v[28:31], v[36:39]
    s_cmp_lt_u32 s65, 8
    s_cbranch_scc1 GQ2
    s_branch GE
GC1:
    s_waitcnt lgkmcnt(3)
    v_mfma_f32_16x16x32_bf16 v[40:43], v[112:115], v[16:19], 0
    s_waitcnt lgkmcnt(2)
    v_mfma_f32_16x16x32_bf16 v[44:47], v[112:115], v[20:23], 0
    s_waitcnt lgkmcnt(1)
    v_mfma_f32_16x16x32_bf16 v[40:43], v[116:119], v[24:27], v[40:43]
    s_waitcnt lgkmcnt(0)
    v_mfma_f32_16x16x32_bf16 v[44:47], v[116:119], v[28:31], v[44:47]
    s_cmp_lt_u32 s65, 8
    s_cbranch_scc1 GQ2
    s_branch GE
GC2:
    s_waitcnt lgkmcnt(3)
    v_mfma_f32_16x16x32_bf16 v[48:51], v[120:123], v[16:19], 0
    s_waitcnt lgkmcnt(2)
    v_mfma_f32_16x16x32_bf16 v[52:55], v[120:123], v[20:23], 0
    s_waitcnt lgkmcnt(1)
    v_mfma_f32_16x16x32_bf16 v[48:51], v[124:127], v[24:27], v[48:51]
    s_waitcnt lgkmcnt(0)
    v_mfma_f32_16x16x32_bf16 v[52:55], v[124:127], v[28:31], v[52:55]
    s_cmp_lt_u32 s65, 8
    s_cbranch_scc1 GQ2
    s_branch GE
GC4:
    s_waitcnt lgkmcnt(3)
    v_mfma_f32_16x16x32_bf16 v[64:67], v[136:139], v[16:19], 0
    s_waitcnt lgkmcnt(2)
    v_mfma_f32_16x16x32_bf16 v[68:71], v[136:139], v[20:23], 0
    s_waitcnt lgkmcnt(1)
    v_mfma_f32_16x16x32_bf16 v[64:67], v[140:143], v[24:27], v[64:67]
    s_waitcnt lgkmcnt(0)
    v_mfma_f32_16x16x32_bf16 v[68:71], v[140:143], v[28:31], v[68:71]
    s_cmp_lt_u32 s65, 8
    s_cbranch_scc1 GQ2
    s_branch GE
GC5:
    s_waitcnt lgkmcnt(3)
    v_mfma_f32_16x16x32_bf16 v[72:75], v[144:147], v[16:19], 0
    s_waitcnt lgkmcnt(2)
    v_mfma_f32_16x16x32_bf16 v[76:79], v[144:147], v[20:23], 0
    s_waitcnt lgkmcnt(1)
    v_mfma_f32_16x16x32_bf16 v[72:75], v[148:151], v[24:27], v[72:75]
    s_waitcnt lgkmcnt(0)
    v_mfma_f32_16x16x32_bf16 v[76:79], v[148:151], v[28:31], v[76:79]
    s_cmp_lt_u32 s65, 8
    s_cbranch_scc1 GQ2
    s_branch GE
GC6:
    s_waitcnt lgkmcnt(3)
    v_mfma_f32_16x16x32_bf16 v[80:83], v[152:155], v[16:19], 0
    s_waitcnt lgkmcnt(2)
    v_mfma_f32_16x16x32_bf16 v[84:87], v[152:155], v[20:23], 0
    s_waitcnt lgkmcnt(1)
    v_mfma_f32_16x16x32_bf16 v[80:83], v[156:159], v[24:27], v[80:83]
    s_waitcnt lgkmcnt(0)
    v_mfma_f32_16x16x32_bf16 v[84:87], v[156:159], v[28:31], v[84:87]
    s_cmp_lt_u32 s65, 8
    s_cbranch_scc1 GQ2
GE:
    s_nop 7
    v_pk_add_f32 v[32:33], v[32:33], v[40:41]
    v_pk_add_f32 v[34:35], v[34:35], v[42:43]
    v_pk_add_f32 v[36:37], v[36:37], v[44:45]
    v_pk_add_f32 v[38:39], v[38:39], v[46:47]
    v_pk_add_f32 v[48:49], v[48:49], v[56:57]
    v_pk_add_f32 v[50:51], v[50:51], v[58:59]
    v_pk_add_f32 v[52:53], v[52:53], v[60:61]
    v_pk_add_f32 v[54:55], v[54:55], v[62:63]
    v_pk_add_f32 v[64:65], v[64:65], v[72:73]
    v_pk_add_f32 v[66:67], v[66:67], v[74:75]
    v_pk_add_f32 v[68:69], v[68:69], v[76:77]
    v_pk_add_f32 v[70:71], v[70:71], v[78:79]
    v_pk_add_f32 v[80:81], v[80:81], v[88:89]
    v_pk_add_f32 v[82:83], v[82:83], v[90:91]
    v_pk_add_f32 v[84:85], v[84:85], v[92:93]
    v_pk_add_f32 v[86:87], v[86:87], v[94:95]
    v_pk_add_f32 v[32:33], v[32:33], v[48:49]
    v_pk_add_f32 v[34:35], v[34:35], v[50:51]
    v_pk_add_f32 v[36:37], v[36:37], v[52:53]
    v_pk_add_f32 v[38:39], v[38:39], v[54:55]
    v_pk_add_f32 v[64:65], v[64:65], v[80:81]
    v_pk_add_f32 v[66:67], v[66:67], v[82:83]
    v_pk_add_f32 v[68:69], v[68:69], v[84:85]
    v_pk_add_f32 v[70:71], v[70:71], v[86:87]
    v_pk_add_f32 v[32:33], v[32:33], v[64:65]
    v_pk_add_f32 v[34:35], v[34:35], v[66:67]
    v_pk_add_f32 v[36:37], v[36:37], v[68:69]
    v_pk_add_f32 v[38:39], v[38:39], v[70:71]
    v_cvt_pk_bf16_f32 v16, v32, v33
    v_cvt_pk_bf16_f32 v17, v34, v35
    v_cvt_pk_bf16_f32 v18, v36, v37
    v_cvt_pk_bf16_f32 v19, v38, v39
    s_nop 1
    v_permlane16_swap_b32 v16, v18
    v_permlane16_swap_b32 v17, v19
    buffer_store_dwordx4 v[16:19], v14, s[36:39], s56 offen
    s_endpgm
CK1:
LW32:
    ds_read_b32 v97, v1 offset:184
    s_waitcnt lgkmcnt(0)
    v_cmp_gt_u32 vcc, 1, v97
    s_cbranch_vccnz LW32
LWX32:
    s_branch CK1R
CK2:
LW33:
    ds_read_b32 v97, v1 offset:188
    s_waitcnt lgkmcnt(0)
    v_cmp_gt_u32 vcc, 2, v97
    s_cbranch_vccnz LW33
LWX33:
    s_branch CK2R
LQ:
LQPAD:
    s_branch HPATH
LQ2:
    v_bfe_u32 v10, v2, 4, 1
    v_lshlrev_b32 v10, 2, v10
    v_xor_b32 v10, v10, v6
    v_lshlrev_b32 v10, 4, v10
    v_mul_u32_u24 v8, 3072, v4
    v_add_u32 v24, v8, v10
    v_add_u32 v25, 23552, v24
    v_add_u32 v26, 23552, v25
    v_add_u32 v27, 23552, v26
    s_mov_b32 s56, 0
    s_mov_b32 s59, s55
    s_mov_b32 s67, 65536
LQL:
    s_cmp_eq_u32 s56, 0
    s_cbranch_scc1 LQW
    s_cmp_eq_u32 s56, 1
    s_cbranch_scc1 LQV
    s_waitcnt vmcnt(32)
LQV:
    s_waitcnt vmcnt(40)
LQW:
    s_waitcnt vmcnt(48)
    s_barrier
    s_and_b32 s59, s59, 7
    s_mul_i32 s65, s59, 196608
    s_add_u32 s65, s65, s58
    s_add_u32 m0, s67, 0
    s_add_u32 s65, s65, 0
    buffer_load_dwordx4 v24, s[36:39], s65 offen offset:0 lds
    buffer_load_dwordx4 v25, s[36:39], s65 offen offset:1024 lds
    buffer_load_dwordx4 v26, s[36:39], s65 offen offset:2048 lds
    buffer_load_dwordx4 v27, s[36:39], s65 offen offset:3072 lds
    s_add_u32 m0, s67, 4096
    s_add_u32 s65, s65, 98304
    buffer_load_dwordx4 v24, s[36:39], s65 offen offset:0 lds
    buffer_load_dwordx4 v25, s[36:39], s65 offen offset:1024 lds
    buffer_load_dwordx4 v26, s[36:39], s65 offen offset:2048 lds
    buffer_load_dwordx4 v27, s[36:39], s65 offen offset:3072 lds
    s_add_u32 s59, s59, 2
    s_and_b32 s59, s59, 7
    s_mul_i32 s65, s59, 196608
    s_add_u32 s65, s65, s58
    s_add_u32 m0, s67, 8192
    s_add_u32 s65, s65, 0
    buffer_load_dwordx4 v24, s[36:39], s65 offen offset:0 lds
    buffer_load_dwordx4 v25, s[36:39], s65 offen offset:1024 lds
    buffer_load_dwordx4 v26, s[36:39], s65 offen offset:2048 lds
    buffer_load_dwordx4 v27, s[36:39], s65 offen offset:3072 lds
    s_add_u32 m0, s67, 12288
    s_add_u32 s65, s65, 98304
    buffer_load_dwordx4 v24, s[36:39], s65 offen offset:0 lds
    buffer_load_dwordx4 v25, s[36:39], s65 offen offset:1024 lds
    buffer_load_dwordx4 v26, s[36:39], s65 offen offset:2048 lds
    buffer_load_dwordx4 v27, s[36:39], s65 offen offset:3072 lds
    s_cmp_eq_u32 s56, 1
    s_addc_u32 s59, s59, 2
    s_add_u32 s67, s67, 16384
    s_add_u32 s56, s56, 1
    s_cmp_lt_u32 s56, 4
    s_cbranch_scc1 LQL
    s_mov_b64 exec, 1
    ds_write_b32 v1, v54 offset:8
    v_mov_b32 v9, 1
    s_waitcnt vmcnt(32)
    ds_write_b32 v1, v9 offset:4
    v_mov_b32 v9, 2
    s_waitcnt vmcnt(16)
    ds_write_b32 v1, v9 offset:4
    v_mov_b32 v9, 3
    s_waitcnt vmcnt(0)
    ds_write_b32 v1, v9 offset:4
    s_mov_b64 exec, -1
    s_setprio 3
    s_mov_b32 s28, s26
    s_and_b32 s29, s27, 0xffff
    s_mov_b32 s30, 18874368
    s_mov_b32 s31, 0x00020000
NL1:
    ds_read_b64 v[14:15], v1 offset:160
    s_waitcnt lgkmcnt(0)
    v_cmp_eq_u32 vcc, 0, v14
    s_cbranch_vccnz NL1
    v_readfirstlane_b32 s60, v14
    v_readfirstlane_b32 s61, v15
LW2:
    s_sleep 1
    ds_read_b32 v61, v1 offset:152
    s_waitcnt lgkmcnt(0)
    v_cmp_gt_u32 vcc, 8, v61
    s_cbranch_vccnz LW2
LWX2:
L0B:
    s_lshl_b32 s64, s54, 6
    s_lshl_b32 s65, s51, 3
    s_add_u32 s64, s64, s65
    s_lshl_b32 s64, s64, 10
    s_add_u32 s64, s64, 0
    s_lshl_b32 s57, s54, 17
    s_add_u32 s57, s57, 2097152
    s_lshl_b32 s65, s51, 14
    s_lshl_b32 s58, s51, 2
    s_lshl_b32 s58, 15, s58
    s_lshl_b32 s62, s48, 11
    s_add_u32 s62, s62, 12599296
    s_mov_b32 s63, 0
    s_mov_b32 exec_hi, 0
    s_mov_b32 exec_lo, s58
POLL3:
    s_sleep 3
    buffer_load_dwordx2 v[60:61], v12, s[28:31], s62 offen sc1
    s_add_u32 s63, s63, 1
    s_cmp_gt_u32 s63, 0x40000
    s_cbranch_scc1 POLLX3
    s_waitcnt vmcnt(0)
    v_cmp_ne_u64 vcc, s[60:61], v[60:61]
    s_cbranch_vccz POLLX3
    s_branch POLL3
POLLX3:
    s_mov_b64 exec, -1
    s_mov_b32 m0, 57344
    s_nop 0
KVL0:
    buffer_load_dwordx4 v3, s[28:31], s64 offen offset:0 sc1 lds
    buffer_load_dwordx4 v3, s[28:31], s64 offen offset:1024 sc1 lds
    buffer_load_dwordx4 v3, s[28:31], s64 offen offset:2048 sc1 lds
    buffer_load_dwordx4 v3, s[28:31], s64 offen offset:3072 sc1 lds
    s_add_u32 m0, m0, 4096
    s_add_u32 s64, s64, 4096
    s_cmp_lt_u32 m0, 65536
    s_cbranch_scc1 KVL0
    s_mov_b32 m0, 0
KVL1:
    s_add_u32 s59, s57, s65
    buffer_load_dwordx4 v3, s[28:31], s59 offen offset:0 sc1 lds
    buffer_load_dwordx4 v3, s[28:31], s59 offen offset:1024 sc1 lds
    buffer_load_dwordx4 v3, s[28:31], s59 offen offset:2048 sc1 lds
    buffer_load_dwordx4 v3, s[28:31], s59 offen offset:3072 sc1 lds
    s_add_u32 m0, m0, 4096
    s_add_u32 s65, s65, 4096
    s_and_b32 s65, s65, 0x1ffff
    s_cmp_lt_u32 m0, 16384
    s_cbranch_scc1 KVL1
    s_mov_b32 exec_hi, 0
    buffer_load_dwordx2 v[60:61], v12, s[28:31], s62 offen sc1
    s_mov_b64 exec, -1
    s_waitcnt vmcnt(1)
    s_barrier
    s_waitcnt vmcnt(0)
    s_mov_b32 exec_hi, 0
    v_cmp_ne_u64 vcc, s[60:61], v[60:61]
    s_mov_b64 exec, -1
    s_cbranch_vccz F1OK
    s_lshl_b32 s62, s48, 11
    s_add_u32 s62, s62, 12599296
    s_mov_b32 s63, 0
    s_mov_b32 exec_hi, 0
POLL4:
    buffer_load_dwordx2 v[60:61], v12, s[28:31], s62 offen sc1
    s_add_u32 s63, s63, 1
    s_cmp_gt_u32 s63, 0x40000
    s_cbranch_scc1 POLLX4
    s_waitcnt vmcnt(0)
    v_cmp_ne_u64 vcc, s[60:61], v[60:61]
    s_cbranch_vccz POLLX4
    s_sleep 2
    s_branch POLL4
POLLX4:
    s_mov_b64 exec, -1
F1OK:
    s_mov_b32 m0, 16384
KVL2:
    s_add_u32 s59, s57, s65
    buffer_load_dwordx4 v3, s[28:31], s59 offen offset:0 sc1 lds
    buffer_load_dwordx4 v3, s[28:31], s59 offen offset:1024 sc1 lds
    buffer_load_dwordx4 v3, s[28:31], s59 offen offset:2048 sc1 lds
    buffer_load_dwordx4 v3, s[28:31], s59 offen offset:3072 sc1 lds
    s_add_u32 m0, m0, 4096
    s_add_u32 s65, s65, 4096
    s_and_b32 s65, s65, 0x1ffff
    s_cmp_lt_u32 m0, 57344
    s_cbranch_scc1 KVL2
    s_waitcnt vmcnt(20)
    ds_write_b32 v1, v54 offset:184
LW5:
    ds_read_b32 v61, v1 offset:192
    s_waitcnt lgkmcnt(0)
    v_cmp_gt_u32 vcc, 8, v61
    s_cbranch_vccnz LW5
LWX5:
    s_mov_b32 m0, 57344
KVL3:
    s_add_u32 s59, s57, s65
    buffer_load_dwordx4 v3, s[28:31], s59 offen offset:0 sc1 lds
    buffer_load_dwordx4 v3, s[28:31], s59 offen offset:1024 sc1 lds
    buffer_load_dwordx4 v3, s[28:31], s59 offen offset:2048 sc1 lds
    buffer_load_dwordx4 v3, s[28:31], s59 offen offset:3072 sc1 lds
    s_add_u32 m0, m0, 4096
    s_add_u32 s65, s65, 4096
    s_and_b32 s65, s65, 0x1ffff
    s_cmp_lt_u32 m0, 131072
    s_cbranch_scc1 KVL3
    s_waitcnt vmcnt(0)
    s_mov_b64 exec, 1
    ds_add_u32 v1, v54 offset:188
    s_mov_b64 exec, -1
    s_lshl_b32 s64, s48, 3
    s_add_u32 s64, s64, s51
    s_lshl_b32 s64, s64, 15
    s_add_u32 s64, s64, 6291456
    s_lshl_b32 s62, s48, 3
    s_add_u32 s62, s62, s51
    s_lshl_b32 s62, s62, 11
    s_add_u32 s62, s62, 12632064
    s_mov_b32 s56, 0x11111111
    s_mov_b32 s57, 0
    s_mov_b32 s63, 0
    v_add_u32 v8, 200, v1
    s_barrier
TP:
    s_mov_b32 exec_hi, 0
    buffer_load_dwordx2 v[60:61], v12, s[28:31], s62 offen sc1
    s_waitcnt vmcnt(1)
TPA:
    s_cmp_eq_u32 s57, 0
    s_cbranch_scc1 TPB
    s_ff1_i32_b32 s58, s57
    s_bitset0_b32 s57, s58
    s_add_u32 s58, s58, 4
    v_mov_b32 v9, s58
    ds_write_b32 v8, v9
    v_add_u32 v8, 4, v8
    s_branch TPA
TPB:
    s_cmp_eq_u32 s56, 0
    s_cbranch_scc1 TPX
    s_waitcnt vmcnt(0)
    v_cmp_eq_u64 vcc, s[60:61], v[60:61]
    s_mov_b64 exec, -1
    s_add_u32 s63, s63, 1
    s_cmp_gt_u32 s63, 0x40000
    s_cselect_b32 s58, -1, vcc_lo
    s_lshr_b32 s59, s58, 1
    s_and_b32 s58, s58, s59
    s_lshr_b32 s59, s58, 2
    s_and_b32 s58, s58, s59
    s_and_b32 s57, s58, s56
    s_andn2_b32 s56, s56, s57
    s_mov_b32 s59, s57
TPC:
    s_cmp_eq_u32 s59, 0
    s_cbranch_scc1 TP
    s_ff1_i32_b32 s58, s59
    s_bitset0_b32 s59, s58
    s_lshl_b32 s58, s58, 10
    s_add_u32 m0, s58, 4096
    s_add_u32 s65, s64, s58
    buffer_load_dwordx4 v3, s[28:31], s65 offen offset:0 sc1 lds
    buffer_load_dwordx4 v3, s[28:31], s65 offen offset:1024 sc1 lds
    buffer_load_dwordx4 v3, s[28:31], s65 offen offset:2048 sc1 lds
    buffer_load_dwordx4 v3, s[28:31], s65 offen offset:3072 sc1 lds
    s_branch TPC
TPX:
    s_mov_b64 exec, -1
    s_cmp_lg_u32 s2, 0
    s_cbranch_scc1 HEND
    s_mov_b32 s44, s24
    s_and_b32 s45, s25, 0xffff
    s_mov_b32 s46, 256
    s_mov_b32 s47, 0x00020000
    v_mov_b32 v14, 0
    v_mov_b32 v15, 0
    s_mov_b64 exec, 1
    buffer_store_dwordx2 v[14:15], v13, s[44:47], 0 offen sc1
    s_mov_b64 exec, -1
    s_endpgm
HPATH:
    s_memrealtime s[60:61]
HP3:
    s_waitcnt lgkmcnt(0)
    s_mov_b32 s28, s26
    s_and_b32 s29, s27, 0xffff
    s_mov_b32 s30, 18874368
    s_mov_b32 s31, 0x00020000
    s_mov_b32 s40, s12
    s_and_b32 s41, s13, 0xffff
    s_mov_b32 s42, 2097152
    s_mov_b32 s43, 0x00020000
    s_xor_b32 s56, s3, 11
    s_or_b32 s56, s56, s2
    s_cmp_lg_u32 s56, 0
    s_cbranch_scc1 HP4
    s_mov_b32 s44, s24
    s_and_b32 s45, s25, 0xffff
    s_mov_b32 s46, 256
    s_mov_b32 s47, 0x00020000
    s_or_b32 s60, s60, 1
    v_mov_b32 v14, s60
    v_mov_b32 v15, s61
    s_mov_b64 exec, 1
    buffer_store_dwordx2 v[14:15], v13, s[44:47], 0 offen sc1
    s_mov_b64 exec, -1
HP4:
    s_cmp_eq_u32 s3, 10
    s_cbranch_scc1 H10
    s_cmp_eq_u32 s3, 11
    s_cbranch_scc1 H11
    v_lshl_add_u32 v8, v2, 2, v1
    ds_write_b32 v8, v13
    s_mov_b32 s44, s24
    s_and_b32 s45, s25, 0xffff
    s_mov_b32 s46, 256
    s_mov_b32 s47, 0x00020000
    s_waitcnt lgkmcnt(0)
    s_barrier
    buffer_load_dwordx2 v[14:15], v13, s[44:47], 0 offen sc1
    s_barrier
    s_barrier
    s_waitcnt vmcnt(0)
    v_cmp_ne_u32 vcc, 0, v14
    s_cbranch_vccnz NOK1
    buffer_load_dwordx2 v[14:15], v13, s[44:47], 0 offen sc1
NOK1:
    s_barrier
    s_barrier
    s_barrier
    s_mov_b32 s63, 0
LD2P:
    s_waitcnt vmcnt(0)
    v_cmp_ne_u32 vcc, 0, v14
    s_cbranch_vccnz LD2Q
    s_add_u32 s63, s63, 1
    v_mov_b32 v14, 1
    s_cmp_gt_u32 s63, 0x40000
    s_cbranch_scc1 LD2Q
    buffer_load_dwordx2 v[14:15], v13, s[44:47], 0 offen sc1
    s_branch LD2P
LD2Q:
    s_lshl_b32 s62, s49, 6
    s_lshl_b32 s63, s48, 11
    s_add_u32 s62, s62, s63
    s_add_u32 s62, s62, 12582912
    s_mov_b64 exec, 1
    buffer_store_dwordx2 v[14:15], v13, s[28:31], s62 offen sc1
    s_mov_b64 exec, -1
    ds_write_b64 v1, v[14:15] offset:160
    s_waitcnt lgkmcnt(0)
    v_readfirstlane_b32 s60, v14
    v_readfirstlane_b32 s61, v15
    s_lshl_b32 s56, s50, 1
    s_barrier
    s_barrier
    s_barrier
    s_barrier
LW6:
    s_sleep 1
    ds_read_b32 v61, v1 offset:152
    s_waitcnt lgkmcnt(0)
    v_cmp_gt_u32 vcc, 8, v61
    s_cbranch_vccnz LW6
LWX6:
    s_lshl_b32 s62, s53, 6
    s_lshl_b32 s63, s52, 11
    s_add_u32 s62, s62, s63
    s_add_u32 s62, s62, 12599296
    s_mov_b64 exec, 1
    buffer_store_dwordx2 v[14:15], v13, s[28:31], s62 offen sc1
    s_mov_b64 exec, -1
    s_barrier
LW7:
    s_sleep 4
    ds_read_b32 v61, v1 offset:184
    s_waitcnt lgkmcnt(0)
    v_cmp_gt_u32 vcc, 1, v61
    s_cbranch_vccnz LW7
LWX7:
    s_lshl_b32 s62, s56, 11
    s_add_u32 s62, s62, 12582912
    s_mov_b32 s63, 0
POLL8:
    buffer_load_dwordx2 v[60:61], v12, s[28:31], s62 offen sc1
    s_add_u32 s63, s63, 1
    s_cmp_gt_u32 s63, 0x40000
    s_cbranch_scc1 POLLX8
    s_waitcnt vmcnt(0)
    v_cmp_ne_u64 vcc, s[60:61], v[60:61]
    s_cbranch_vccz POLLX8
    s_sleep 2
    s_branch POLL8
POLLX8:
    s_mov_b64 exec, -1
    s_mov_b64 exec, 1
    ds_add_u32 v1, v54 offset:188
    s_mov_b64 exec, -1
    s_endpgm
H11:
    s_mov_b32 s40, s20
    s_and_b32 s41, s21, 0xffff
    s_mov_b32 s42, 524288
    s_mov_b32 s43, 0x00020000
    v_lshlrev_b32 v16, 10, v4
    v_lshl_add_u32 v16, v6, 4, v16
    s_lshl_b32 s56, s49, 14
    s_lshl_b32 s57, s48, 7
    s_add_u32 s56, s56, s57
    s_add_u32 s57, s56, 7168
    v_lshrrev_b32 v17, 5, v2
    v_bfe_u32 v18, v2, 2, 2
    v_lshl_add_u32 v17, v17, 2, v18
    v_lshlrev_b32 v17, 7, v17
    v_bfe_u32 v18, v2, 4, 1
    v_lshl_add_u32 v17, v18, 5, v17
    v_and_b32 v18, 3, v2
    v_lshl_add_u32 v17, v18, 3, v17
    s_lshl_b32 s58, s48, 16
    s_lshr_b32 s59, s49, 1
    s_lshl_b32 s59, s59, 10
    s_add_u32 s58, s58, s59
    s_and_b32 s59, s49, 1
    s_lshl_b32 s59, s59, 9
    s_add_u32 s58, s58, s59
    v_and_b32 v19, 15, v2
    v_lshlrev_b32 v19, 4, v19
    v_lshrrev_b32 v18, 5, v2
    v_lshl_add_u32 v19, v18, 8, v19
    v_bfe_u32 v18, v2, 4, 1
    v_lshl_add_u32 v19, v18, 14, v19
    v_add_u32 v17, 157696, v17
    s_add_u32 s58, s58, 13631488
    s_add_u32 s59, s58, 32768
    s_mov_b32 m0, 157696
    s_nop 0
    buffer_load_dwordx4 v16, s[40:43], s56 offen lds
    buffer_load_dwordx4 v16, s[40:43], s57 offen offset:1024 lds
    s_barrier
    s_barrier
    s_waitcnt vmcnt(0)
    ds_read_b64_tr_b16 v[20:21], v17
    ds_read_b64_tr_b16 v[22:23], v17 offset:1024
    ds_read_b64_tr_b16 v[24:25], v17 offset:64
    ds_read_b64_tr_b16 v[26:27], v17 offset:1088
    s_waitcnt lgkmcnt(0)
    buffer_store_dwordx4 v[20:23], v19, s[28:31], s58 offen sc1
    buffer_store_dwordx4 v[24:27], v19, s[28:31], s59 offen sc1
    s_mov_b32 s40, s12
    s_and_b32 s41, s13, 0xffff
    s_mov_b32 s42, 2097152
    s_mov_b32 s43, 0x00020000
    s_lshl_b32 s64, s66, 13
    v_and_b32 v8, 1, v2
    v_mul_u32_u24 v8, 8324, v8
    v_add_u32 v8, 146496, v8
    s_barrier
    s_barrier
    s_barrier
    s_waitcnt vmcnt(0)
    s_barrier
    s_barrier
    s_barrier
    s_mov_b32 m0, 146496
    s_add_u32 s65, s64, 0
    buffer_load_dwordx4 v3, s[40:43], s65 offen offset:0 lds
    buffer_load_dwordx4 v3, s[40:43], s65 offen offset:1024 lds
    buffer_load_dwordx4 v3, s[40:43], s65 offen offset:2048 lds
    buffer_load_dwordx4 v3, s[40:43], s65 offen offset:3072 lds
    s_mov_b32 m0, 154820
    s_add_u32 s65, s64, 4096
    buffer_load_dwordx4 v3, s[40:43], s65 offen offset:0 lds
    buffer_load_dwordx4 v3, s[40:43], s65 offen offset:1024 lds
    buffer_load_dwordx4 v3, s[40:43], s65 offen offset:2048 lds
    buffer_load_dwordx4 v3, s[40:43], s65 offen offset:3072 lds
    s_barrier
    s_barrier
LW9:
    ds_read_b32 v62, v1 offset:8
    s_waitcnt lgkmcnt(0)
    v_cmp_gt_u32 vcc, 1, v62
    s_cbranch_vccnz LW9
LWX9:
    s_mov_b32 m0, 158984
    s_add_u32 s65, s64, 4098
    buffer_load_dwordx4 v3, s[40:43], s65 offen offset:0 lds
    buffer_load_dwordx4 v3, s[40:43], s65 offen offset:1024 lds
    buffer_load_dwordx4 v3, s[40:43], s65 offen offset:2048 lds
    buffer_load_dwordx4 v3, s[40:43], s65 offen offset:3072 lds
    s_mov_b32 m0, 150660
    s_add_u32 s65, s64, 2
    buffer_load_dwordx4 v3, s[40:43], s65 offen offset:0 lds
    buffer_load_dwordx4 v3, s[40:43], s65 offen offset:1024 lds
    buffer_load_dwordx4 v3, s[40:43], s65 offen offset:2048 lds
    buffer_load_dwordx4 v3, s[40:43], s65 offen offset:3072 lds
    s_waitcnt vmcnt(8)
    ds_read_b32 v9, v8
    s_waitcnt lgkmcnt(0)
    v_lshlrev_b32 v9, 16, v9
    s_mov_b64 exec, 3
    ds_write_b32 v8, v9 offset:4160
    s_mov_b64 exec, -1
    s_waitcnt vmcnt(4) lgkmcnt(0)
    s_mov_b64 exec, 1
    ds_add_u32 v1, v54 offset:180
    s_mov_b64 exec, -1
    s_waitcnt vmcnt(0)
    s_mov_b64 exec, 1
    ds_add_u32 v1, v54 offset:176
    s_mov_b64 exec, -1
    s_endpgm
H10:
    v_mov_b32 v32, 0
    v_mov_b32 v33, 0
    v_mov_b32 v34, 0
    v_mov_b32 v35, 0
    s_lshl_b32 s64, s66, 13
    s_barrier
    s_barrier
    s_barrier
    v_add_u32 v8, 131072, v3
    ds_write_b128 v8, v[32:35] offset:4096
    v_add_u32 v8, 138752, v3
    ds_write_b128 v8, v[32:35] offset:4096
    v_lshlrev_b32 v8, 2, v2
    v_add_u32 v8, 146432, v8
    s_mov_b64 exec, 0xffff
    ds_write_b32 v8, v32
    ds_write_b32 v8, v32 offset:4160
    ds_write_b32 v8, v32 offset:8324
    ds_write_b32 v8, v32 offset:12484
    s_mov_b64 exec, -1
    s_lshl_b32 s62, s48, 11
    s_add_u32 s62, s62, 12582912
    s_barrier
    s_barrier
    s_barrier
    s_barrier
NL10:
    ds_read_b64 v[14:15], v1 offset:160
    s_waitcnt lgkmcnt(0)
    v_cmp_eq_u32 vcc, 0, v14
    s_cbranch_vccnz NL10
    v_readfirstlane_b32 s60, v14
    v_readfirstlane_b32 s61, v15
    s_barrier
    s_barrier
    s_mov_b32 exec_hi, 0
    buffer_load_dwordx2 v[60:61], v12, s[28:31], s62 offen sc1
    s_mov_b64 exec, -1
    s_barrier
LW11:
    ds_read_b32 v62, v1 offset:8
    s_waitcnt lgkmcnt(0)
    v_cmp_gt_u32 vcc, 1, v62
    s_cbranch_vccnz LW11
LWX11:
    s_waitcnt vmcnt(0)
    s_mov_b32 exec_hi, 0
    v_cmp_ne_u64 vcc, s[60:61], v[60:61]
    s_mov_b64 exec, -1
    s_cbranch_vccz F0OK
    s_lshl_b32 s62, s48, 11
    s_add_u32 s62, s62, 12582912
    s_mov_b32 s63, 0
    s_mov_b32 exec_hi, 0
POLL12:
    buffer_load_dwordx2 v[60:61], v12, s[28:31], s62 offen sc1
    s_add_u32 s63, s63, 1
    s_cmp_gt_u32 s63, 0x40000
    s_cbranch_scc1 POLLX12
    s_waitcnt vmcnt(0)
    v_cmp_ne_u64 vcc, s[60:61], v[60:61]
    s_cbranch_vccz POLLX12
    s_sleep 2
    s_branch POLL12
POLLX12:
    s_mov_b64 exec, -1
F0OK:
    s_add_u32 s64, s64, 8388608
    s_mov_b32 m0, 138752
    s_add_u32 s65, s64, 4096
    buffer_load_dwordx4 v3, s[28:31], s65 offen offset:0 sc1 lds
    buffer_load_dwordx4 v3, s[28:31], s65 offen offset:1024 sc1 lds
    buffer_load_dwordx4 v3, s[28:31], s65 offen offset:2048 sc1 lds
    buffer_load_dwordx4 v3, s[28:31], s65 offen offset:3072 sc1 lds
    s_mov_b32 m0, 131072
    s_add_u32 s65, s64, 0
    buffer_load_dwordx4 v3, s[28:31], s65 offen offset:0 sc1 lds
    buffer_load_dwordx4 v3, s[28:31], s65 offen offset:1024 sc1 lds
    buffer_load_dwordx4 v3, s[28:31], s65 offen offset:2048 sc1 lds
    buffer_load_dwordx4 v3, s[28:31], s65 offen offset:3072 sc1 lds
    s_waitcnt vmcnt(4)
    s_mov_b64 exec, 1
    ds_add_u32 v1, v54 offset:180
    s_mov_b64 exec, -1
    s_waitcnt vmcnt(0)
    s_mov_b64 exec, 1
    ds_add_u32 v1, v54 offset:176
    s_mov_b64 exec, -1
    s_lshl_b32 s64, s48, 18
    s_lshl_b32 s65, s49, 7
    s_add_u32 s64, s64, s65
    s_add_u32 s64, s64, 10485760
    v_xor_b32 v8, 0, v6
    v_lshlrev_b32 v8, 4, v8
    v_lshl_add_u32 v16, v4, 12, v8
    v_xor_b32 v8, 1, v6
    v_lshlrev_b32 v8, 4, v8
    v_lshl_add_u32 v17, v4, 12, v8
    v_xor_b32 v8, 2, v6
    v_lshlrev_b32 v8, 4, v8
    v_lshl_add_u32 v18, v4, 12, v8
    v_xor_b32 v8, 3, v6
    v_lshlrev_b32 v8, 4, v8
    v_lshl_add_u32 v19, v4, 12, v8
    v_xor_b32 v8, 4, v6
    v_lshlrev_b32 v8, 4, v8
    v_lshl_add_u32 v20, v4, 12, v8
    v_xor_b32 v8, 5, v6
    v_lshlrev_b32 v8, 4, v8
    v_lshl_add_u32 v21, v4, 12, v8
    v_xor_b32 v8, 6, v6
    v_lshlrev_b32 v8, 4, v8
    v_lshl_add_u32 v22, v4, 12, v8
    v_xor_b32 v8, 7, v6
    v_lshlrev_b32 v8, 4, v8
    v_lshl_add_u32 v23, v4, 12, v8
    s_barrier
LW13:
    s_sleep 36
    ds_read_b32 v61, v1 offset:196
    s_waitcnt lgkmcnt(0)
    v_cmp_gt_u32 vcc, 8, v61
    s_cbranch_vccnz LW13
LWX13:
    s_lshl_b32 s62, s49, 6
    s_lshl_b32 s63, s48, 11
    s_add_u32 s62, s62, s63
    s_add_u32 s62, s62, 12615680
    s_mov_b64 exec, 1
    buffer_store_dwordx2 v[14:15], v13, s[28:31], s62 offen sc1
    s_mov_b64 exec, -1
    s_lshl_b32 s62, s48, 11
    s_add_u32 s62, s62, 12615680
    s_mov_b32 s63, 0
    s_mov_b32 exec_hi, 0
POLL14:
    s_sleep 64
    buffer_load_dwordx2 v[60:61], v12, s[28:31], s62 offen sc1
    s_add_u32 s63, s63, 1
    s_cmp_gt_u32 s63, 0x40000
    s_cbranch_scc1 POLLX14
    s_waitcnt vmcnt(0)
    v_cmp_ne_u64 vcc, s[60:61], v[60:61]
    s_cbranch_vccz POLLX14
    s_branch POLL14
POLLX14:
    s_mov_b64 exec, -1
    s_mov_b32 m0, 131072
    s_nop 0
    buffer_load_dwordx4 v16, s[28:31], s64 offen sc1 lds
    s_add_u32 s64, s64, 32768
    s_mov_b32 m0, 132096
    s_nop 0
    buffer_load_dwordx4 v17, s[28:31], s64 offen sc1 lds
    s_add_u32 s64, s64, 32768
    s_mov_b32 m0, 133120
    s_nop 0
    buffer_load_dwordx4 v18, s[28:31], s64 offen sc1 lds
    s_add_u32 s64, s64, 32768
    s_mov_b32 m0, 134144
    s_nop 0
    buffer_load_dwordx4 v19, s[28:31], s64 offen sc1 lds
    s_add_u32 s64, s64, 32768
    s_mov_b32 m0, 135168
    s_nop 0
    buffer_load_dwordx4 v20, s[28:31], s64 offen sc1 lds
    s_add_u32 s64, s64, 32768
    s_mov_b32 m0, 136192
    s_nop 0
    buffer_load_dwordx4 v21, s[28:31], s64 offen sc1 lds
    s_add_u32 s64, s64, 32768
    s_mov_b32 m0, 137216
    s_nop 0
    buffer_load_dwordx4 v22, s[28:31], s64 offen sc1 lds
    s_add_u32 s64, s64, 32768
    s_mov_b32 m0, 138240
    s_nop 0
    buffer_load_dwordx4 v23, s[28:31], s64 offen sc1 lds
    s_add_u32 s64, s64, 32768
    s_waitcnt vmcnt(0)
HEND:
    s_endpgm
FALLBACK:
    s_mov_b32 s68, 1
    v_mov_b32 v29, v3
    v_mov_b32 v31, 0xff800000
    s_mov_b32 s65, 0
MAXL:
    ds_read_b128 v[8:11], v29
    v_add_u32 v29, 2048, v29
    s_waitcnt lgkmcnt(0)
    v_mfma_f32_32x32x16_bf16 v[32:47], v[8:11], v[4:7], 0
    s_nop 15
    v_max3_f32 v31, v31, v32, v33
    v_max3_f32 v31, v31, v34, v35
    v_max3_f32 v31, v31, v36, v37
    v_max3_f32 v31, v31, v38, v39
    v_max3_f32 v31, v31, v40, v41
    v_max3_f32 v31, v31, v42, v43
    v_max3_f32 v31, v31, v44, v45
    v_max3_f32 v31, v31, v46, v47
    s_add_u32 s65, s65, 1
    s_cmp_lt_u32 s65, 64
    s_cbranch_scc1 MAXL
    v_mov_b32 v32, v31
    s_nop 1
    v_permlane32_swap_b32 v31, v32
    s_nop 1
    v_max_f32 v31, v31, v32
    v_sub_f32 v80, 0, v31
    v_sub_f32 v81, 0, v31
    v_sub_f32 v82, 0, v31
    v_sub_f32 v83, 0, v31
    v_sub_f32 v84, 0, v31
    v_sub_f32 v85, 0, v31
    v_sub_f32 v86, 0, v31
    v_sub_f32 v87, 0, v31
    v_sub_f32 v88, 0, v31
    v_sub_f32 v89, 0, v31
    v_sub_f32 v90, 0, v31
    v_sub_f32 v91, 0, v31
    v_sub_f32 v92, 0, v31
    v_sub_f32 v93, 0, v31
    v_sub_f32 v94, 0, v31
    v_sub_f32 v95, 0, v31
    v_mov_b32 v29, v3
    v_subrev_u32 v30, 131072, v30
    v_mov_b32 v64, 0
    v_mov_b32 v65, 0
    v_mov_b32 v66, 0
    v_mov_b32 v67, 0
    v_mov_b32 v68, 0
    v_mov_b32 v69, 0
    v_mov_b32 v70, 0
    v_mov_b32 v71, 0
    v_mov_b32 v72, 0
    v_mov_b32 v73, 0
    v_mov_b32 v74, 0
    v_mov_b32 v75, 0
    v_mov_b32 v76, 0
    v_mov_b32 v77, 0
    v_mov_b32 v78, 0
    v_mov_b32 v79, 0
    v_mov_b32 v56, 0
    v_mov_b32 v57, 0
    v_mov_b32 v58, 0
    v_mov_b32 v59, 0
    v_mov_b32 v60, 0
    v_mov_b32 v61, 0
    v_mov_b32 v62, 0
    v_mov_b32 v63, 0
    s_mov_b32 s65, 0
    ds_read_b128 v[8:11], v3
    s_mov_b64 exec, s[66:67]
    ds_read_b128 v[12:15], v30
    ds_read_b128 v[16:19], v30 offset:512
    ds_read_b128 v[24:27], v30 offset:512
    s_mov_b64 exec, -1
    s_waitcnt lgkmcnt(3)
    v_mfma_f32_32x32x16_bf16 v[32:47], v[8:11], v[4:7], v[80:95]
    ds_read_b128 v[8:11], v29 offset:2048
    s_waitcnt lgkmcnt(1)
    s_nop 9
FBL:
    s_setprio 3
    v_exp_f32 v32, v32
    v_exp_f32 v33, v33
    v_smfmac_f32_32x32x32_bf16 v[64:79], v[24:27], v[56:63], v28
    s_mov_b64 exec, s[66:67]
    ds_read_b128 v[20:23], v30 offset:2048
    ds_read_b128 v[24:27], v30 offset:2560
    s_mov_b64 exec, -1
    v_exp_f32 v34, v34
    v_exp_f32 v35, v35
    v_exp_f32 v36, v36
    s_waitcnt lgkmcnt(2)
    v_mfma_f32_32x32x16_bf16 v[48:63], v[8:11], v[4:7], v[80:95]
    ds_read_b128 v[8:11], v29 offset:4096
    v_exp_f32 v37, v37
    v_exp_f32 v38, v38
    v_exp_f32 v39, v39
    v_exp_f32 v40, v40
    v_exp_f32 v41, v41
    v_smfmac_f32_32x32x32_bf16 v[64:79], v[12:15], v[32:39], v28
    v_exp_f32 v42, v42
    v_exp_f32 v43, v43
    v_exp_f32 v44, v44
    v_exp_f32 v45, v45
    v_exp_f32 v46, v46
    v_exp_f32 v47, v47
    s_setprio 2
    v_exp_f32 v48, v48
    v_exp_f32 v49, v49
    v_smfmac_f32_32x32x32_bf16 v[64:79], v[16:19], v[40:47], v28
    s_mov_b64 exec, s[66:67]
    ds_read_b128 v[12:15], v30 offset:4096
    ds_read_b128 v[16:19], v30 offset:4608
    s_mov_b64 exec, -1
    v_exp_f32 v50, v50
    v_exp_f32 v51, v51
    v_exp_f32 v52, v52
    s_waitcnt lgkmcnt(2)
    v_mfma_f32_32x32x16_bf16 v[32:47], v[8:11], v[4:7], v[80:95]
    ds_read_b128 v[8:11], v29 offset:6144
    v_exp_f32 v53, v53
    v_exp_f32 v54, v54
    v_exp_f32 v55, v55
    v_exp_f32 v56, v56
    v_exp_f32 v57, v57
    v_smfmac_f32_32x32x32_bf16 v[64:79], v[20:23], v[48:55], v28
    v_exp_f32 v58, v58
    v_exp_f32 v59, v59
    v_exp_f32 v60, v60
    v_exp_f32 v61, v61
    v_exp_f32 v62, v62
    v_exp_f32 v63, v63
    v_add_u32 v29, 4096, v29
    v_add_u32 v30, 4096, v30
    s_add_u32 s65, s65, 1
    s_cmp_lt_u32 s65, 32
    s_cbranch_scc1 FBL
    s_branch LEXIT
END:
    s_endpgm
.section .rodata,"a"
.p2align 6
.amdhsa_kernel concat_heads__ssm_conv_h3__softmax_full_mha__prompt_kernel
  .amdhsa_next_free_vgpr 168
  .amdhsa_next_free_sgpr 96
  .amdhsa_accum_offset 168
  .amdhsa_group_segment_fixed_size 0
  .amdhsa_kernarg_size 96
  .amdhsa_user_sgpr_count 2
  .amdhsa_user_sgpr_kernarg_segment_ptr 1
  .amdhsa_system_sgpr_workgroup_id_x 1
  .amdhsa_float_denorm_mode_32 3
.end_amdhsa_kernel
```
